```python
import torch

def _softmax(x, axis=-1):
    return torch.softmax(x, dim=axis)
def _gelu(x):
    return torch.nn.functional.gelu(x, approximate="tanh")
def _silu(x):
    return torch.nn.functional.silu(x)
def _sigmoid(x):
    return torch.sigmoid(x)
def _layernorm(x, axis=-1, eps=1e-5):
    m = x.mean(dim=axis, keepdim=True)
    v = x.var(dim=axis, keepdim=True, unbiased=False)
    return (x - m) / torch.sqrt(v + eps)
def _scatter_add(tgt, idx, src, axis=0):
    return tgt.clone().index_add_(axis, idx, src)
def _segment_sum(src, seg, n):
    out = torch.zeros((n,) + src.shape[1:], dtype=src.dtype)
    return out.index_add_(0, seg, src)
def _pad(x, pw):
    flat = tuple(v for pair in reversed(pw) for v in pair)
    return torch.nn.functional.pad(x, flat)

kernel_name = 'standalone__deep_cross_pnn__recsys'

def setup_inputs():

    _w = (lambda a: (lambda t: t.to(torch.bfloat16) if t.is_floating_point() else t)(torch.as_tensor(a)))
    B, F, D, V = 4096, 100, 32, min(1000000, 100000)
    H = 4 * D
    return {
        "idx": _w((lambda lo, hi, *s: torch.randint(lo, hi, s))(0, V, B, F).to(torch.int64)),
        "table": _w((lambda *s: torch.randn(*s, dtype=torch.bfloat16) * 1.6)(V, D) * (D ** -0.5)),
        "w_p": _w((lambda *s: torch.randn(*s, dtype=torch.bfloat16) * 0.05)(F * F) * ((F * F) ** -0.5)),
        "w1": _w((lambda *s: torch.randn(*s, dtype=torch.bfloat16) * 1.6)(F * D, H) * ((F * D) ** -0.5)),
        "b1": _w((lambda *s: torch.randn(*s, dtype=torch.bfloat16) * 1.6)(H) * 0.01),
        "w2": _w((lambda *s: torch.randn(*s, dtype=torch.bfloat16) * 0.05)(H) * (H ** -0.5)),
        "b2": _w((lambda *s: torch.randn(*s, dtype=torch.bfloat16) * 0.05)(1) * 0.01),
    }

def reference(idx, table, w_p, w1, b1, w2, b2):
    emb = table[idx]
    B = emb.shape[0]; F = emb.shape[1]; D = emb.shape[2]
    ip = torch.einsum('bid,bjd->bij', emb, emb)
    ip = ip.reshape(B, F * F)
    logit_p = ip @ w_p
    z = emb.reshape(B, F * D)
    h = _gelu(z @ w1 + b1)
    logit_d = h @ w2 + b2
    return logit_p + logit_d
```

```asm
; @launch grid=(256,1,1) block=(512,1,1) lds=162144
.amdgcn_target "amdgcn-amd-amdhsa--gfx950"
.text
.globl standalone__deep_cross_pnn__recsys_kernel
.p2align 8
.type standalone__deep_cross_pnn__recsys_kernel,@function
standalone__deep_cross_pnn__recsys_kernel:
  s_cmp_ge_u32 s2, 256
  s_cbranch_scc1 L_end
  s_load_dwordx16 s[72:87], s[0:1], 0
  s_load_dwordx2 s[90:91], s[0:1], 72
  v_lshrrev_b32 v1, 6, v0
  v_and_b32 v0, 63, v0
  v_readfirstlane_b32 s33, v1
  s_and_b32 s34, s2, 7
  s_lshr_b32 s35, s2, 5
  s_lshl_b32 s35, s35, 3
  s_add_u32 s34, s34, s35
  s_lshr_b32 s35, s2, 3
  s_and_b32 s35, s35, 3
  v_mov_b32 v255, 161824
  s_cmp_lg_u32 s33, 0
  s_cbranch_scc1 L_noinit
  v_mov_b32 v2, 0
  v_lshlrev_b32 v3, 2, v0
  v_add_u32 v3, 161824, v3
  s_mov_b64 exec, 0xffff
  ds_write_b32 v3, v2
  s_mov_b64 exec, -1
L_noinit:
  s_waitcnt lgkmcnt(0)
  s_barrier
  s_mov_b32 s4, s72
  s_and_b32 s5, s73, 0xffff
  s_mov_b32 s6, 1638400
  s_mov_b32 s7, 0x20000
  s_mov_b32 s8, s74
  s_and_b32 s9, s75, 0xffff
  s_mov_b32 s10, 6400000
  s_mov_b32 s11, 0x20000
  s_cmp_ge_u32 s33, 4
  s_cbranch_scc1 L_pnn
  s_setprio 2
  s_mov_b32 s12, s78
  s_and_b32 s13, s79, 0xffff
  s_mov_b32 s14, 819200
  s_mov_b32 s15, 0x20000
  s_mov_b32 s16, s80
  s_and_b32 s17, s81, 0xffff
  s_mov_b32 s18, 256
  s_mov_b32 s19, 0x20000
  s_mov_b32 s20, s82
  s_and_b32 s21, s83, 0xffff
  s_mov_b32 s22, 256
  s_mov_b32 s23, 0x20000
  v_mov_b32 v253, v0
  s_lshl_b32 s24, s34, 2
  s_add_u32 s24, s24, s33
  s_lshl_b32 s24, s24, 7
  s_add_u32 s24, s24, 17825792
  s_add_u32 s92, s90, s24
  s_addc_u32 s93, s91, 0
  v_mov_b32 v234, 0
  global_load_dword v235, v234, s[92:93] sc1
  v_and_b32 v2, 3, v0
  v_and_b32 v4, 15, v0
  v_lshlrev_b32 v5, 1, v4
  s_lshl_b32 s28, s33, 6
  buffer_load_ushort v236, v5, s[16:19], s28 offen
  buffer_load_ushort v237, v5, s[16:19], s28 offen offset:32
  buffer_load_ushort v238, v5, s[20:23], s28 offen
  buffer_load_ushort v239, v5, s[20:23], s28 offen offset:32
  v_lshrrev_b32 v6, 4, v0
  v_lshlrev_b32 v7, 1, v6
  v_xor_b32 v7, v7, v4
  v_lshlrev_b32 v8, 8, v6
  v_lshl_add_u32 v228, v7, 4, v8
  v_xor_b32 v229, 128, v228
  s_mul_i32 s29, s35, 204800
  s_lshr_b32 s31, s2, 5
  s_bitcmp1_b32 s33, 0
  s_cselect_b64 vcc, -1, 0
  v_cndmask_b32 v228, v228, v229, vcc
  s_lshl_b32 s88, s33, 11
  s_add_u32 s29, s29, s88
  s_mul_i32 s32, s31, 13
  s_lshr_b32 s32, s32, 3
  s_lshl_b32 s28, s32, 13
  s_add_u32 s30, s28, 0
  s_add_u32 m0, s30, s88
  s_add_u32 s30, s28, 0
  s_add_u32 s30, s30, s29
  buffer_load_dwordx4 v228, s[12:15], s30 offen lds
  buffer_load_dwordx4 v228, s[12:15], s30 offen offset:1024 lds
  s_add_u32 s32, s32, 1
  s_cmp_eq_u32 s32, 13
  s_cselect_b32 s32, 0, s32
  s_lshl_b32 s28, s32, 13
  s_add_u32 s30, s28, 0
  s_add_u32 m0, s30, s88
  s_add_u32 s30, s28, 0
  s_add_u32 s30, s30, s29
  buffer_load_dwordx4 v228, s[12:15], s30 offen lds
  buffer_load_dwordx4 v228, s[12:15], s30 offen offset:1024 lds
  s_add_u32 s32, s32, 1
  s_cmp_eq_u32 s32, 13
  s_cselect_b32 s32, 0, s32
  s_lshl_b32 s28, s32, 13
  s_add_u32 s30, s28, 0
  s_add_u32 m0, s30, s88
  s_add_u32 s30, s28, 0
  s_add_u32 s30, s30, s29
  buffer_load_dwordx4 v228, s[12:15], s30 offen lds
  buffer_load_dwordx4 v228, s[12:15], s30 offen offset:1024 lds
  s_add_u32 s32, s32, 1
  s_cmp_eq_u32 s32, 13
  s_cselect_b32 s32, 0, s32
  s_lshl_b32 s28, s32, 13
  s_add_u32 s30, s28, 0
  s_add_u32 m0, s30, s88
  s_add_u32 s30, s28, 0
  s_add_u32 s30, s30, s29
  buffer_load_dwordx4 v228, s[12:15], s30 offen lds
  buffer_load_dwordx4 v228, s[12:15], s30 offen offset:1024 lds
  s_add_u32 s32, s32, 1
  s_cmp_eq_u32 s32, 13
  s_cselect_b32 s32, 0, s32
  s_lshl_b32 s28, s32, 13
  s_add_u32 s30, s28, 0
  s_add_u32 m0, s30, s88
  s_add_u32 s30, s28, 0
  s_add_u32 s30, s30, s29
  buffer_load_dwordx4 v228, s[12:15], s30 offen lds
  buffer_load_dwordx4 v228, s[12:15], s30 offen offset:1024 lds
  s_add_u32 s32, s32, 1
  s_cmp_eq_u32 s32, 13
  s_cselect_b32 s32, 0, s32
  s_lshl_b32 s28, s32, 13
  s_add_u32 s30, s28, 0
  s_add_u32 m0, s30, s88
  s_add_u32 s30, s28, 0
  s_add_u32 s30, s30, s29
  buffer_load_dwordx4 v228, s[12:15], s30 offen lds
  buffer_load_dwordx4 v228, s[12:15], s30 offen offset:1024 lds
  s_add_u32 s32, s32, 1
  s_cmp_eq_u32 s32, 13
  s_cselect_b32 s32, 0, s32
  s_lshl_b32 s28, s32, 13
  s_add_u32 s30, s28, 0
  s_add_u32 m0, s30, s88
  s_add_u32 s30, s28, 0
  s_add_u32 s30, s30, s29
  buffer_load_dwordx4 v228, s[12:15], s30 offen lds
  buffer_load_dwordx4 v228, s[12:15], s30 offen offset:1024 lds
  s_add_u32 s32, s32, 1
  s_cmp_eq_u32 s32, 13
  s_cselect_b32 s32, 0, s32
  s_lshl_b32 s28, s32, 13
  s_add_u32 s30, s28, 0
  s_add_u32 m0, s30, s88
  s_add_u32 s30, s28, 0
  s_add_u32 s30, s30, s29
  buffer_load_dwordx4 v228, s[12:15], s30 offen lds
  buffer_load_dwordx4 v228, s[12:15], s30 offen offset:1024 lds
  s_add_u32 s32, s32, 1
  s_cmp_eq_u32 s32, 13
  s_cselect_b32 s32, 0, s32
  s_lshl_b32 s28, s32, 13
  s_add_u32 s30, s28, 0
  s_add_u32 m0, s30, s88
  s_add_u32 s30, s28, 0
  s_add_u32 s30, s30, s29
  buffer_load_dwordx4 v228, s[12:15], s30 offen lds
  buffer_load_dwordx4 v228, s[12:15], s30 offen offset:1024 lds
  s_add_u32 s32, s32, 1
  s_cmp_eq_u32 s32, 13
  s_cselect_b32 s32, 0, s32
  s_lshl_b32 s28, s32, 13
  s_add_u32 s30, s28, 0
  s_add_u32 m0, s30, s88
  s_add_u32 s30, s28, 0
  s_add_u32 s30, s30, s29
  buffer_load_dwordx4 v228, s[12:15], s30 offen lds
  buffer_load_dwordx4 v228, s[12:15], s30 offen offset:1024 lds
  s_add_u32 s32, s32, 1
  s_cmp_eq_u32 s32, 13
  s_cselect_b32 s32, 0, s32
  s_lshl_b32 s28, s32, 13
  s_add_u32 s30, s28, 0
  s_add_u32 m0, s30, s88
  s_add_u32 s30, s28, 0
  s_add_u32 s30, s30, s29
  buffer_load_dwordx4 v228, s[12:15], s30 offen lds
  buffer_load_dwordx4 v228, s[12:15], s30 offen offset:1024 lds
  s_add_u32 s32, s32, 1
  s_cmp_eq_u32 s32, 13
  s_cselect_b32 s32, 0, s32
  s_lshl_b32 s28, s32, 13
  s_add_u32 s30, s28, 0
  s_add_u32 m0, s30, s88
  s_add_u32 s30, s28, 0
  s_add_u32 s30, s30, s29
  buffer_load_dwordx4 v228, s[12:15], s30 offen lds
  buffer_load_dwordx4 v228, s[12:15], s30 offen offset:1024 lds
  s_add_u32 s32, s32, 1
  s_cmp_eq_u32 s32, 13
  s_cselect_b32 s32, 0, s32
  s_lshl_b32 s28, s32, 13
  s_add_u32 s30, s28, 0
  s_add_u32 m0, s30, s88
  s_add_u32 s30, s28, 0
  s_add_u32 s30, s30, s29
  buffer_load_dwordx4 v228, s[12:15], s30 offen lds
  buffer_load_dwordx4 v228, s[12:15], s30 offen offset:1024 lds
  v_lshrrev_b32 v7, 2, v4
  v_and_b32 v8, 3, v4
  v_and_b32 v9, 1, v6
  v_lshl_add_u32 v9, v9, 2, v7
  v_lshlrev_b32 v9, 1, v9
  s_lshl_b32 s28, s33, 2
  v_xor_b32 v9, s28, v9
  v_lshrrev_b32 v10, 1, v8
  v_or_b32 v9, v9, v10
  v_lshlrev_b32 v9, 4, v9
  v_and_b32 v10, 1, v8
  v_lshl_add_u32 v9, v10, 3, v9
  v_lshl_add_u32 v10, v6, 3, v7
  v_lshl_add_u32 v230, v10, 8, v9
  v_xor_b32 v231, 32, v230
  v_lshrrev_b32 v7, 5, v0
  v_lshlrev_b32 v7, 1, v7
  v_xor_b32 v7, v7, v2
  v_lshlrev_b32 v232, 4, v7
  v_lshrrev_b32 v7, 3, v4
  v_lshlrev_b32 v7, 1, v7
  v_xor_b32 v7, v7, v6
  v_lshl_add_u32 v7, v4, 2, v7
  v_lshlrev_b32 v233, 4, v7
  v_lshlrev_b32 v240, 4, v0
  s_waitcnt vmcnt(30)
  v_readfirstlane_b32 s94, v235
  s_nop 0
  s_add_u32 s94, s94, 1
  v_lshrrev_b32 v7, 2, v4
  v_mul_u32_u24 v7, 26400, v7
  v_lshl_add_u32 v7, v6, 4, v7
  v_and_b32 v8, 3, v4
  s_mul_i32 s24, s35, 25
  s_add_u32 s25, s24, 0
  s_and_b32 s26, s25, 3
  s_lshr_b32 s25, s25, 2
  s_mul_i32 s25, s25, 1056
  s_lshl_b32 s28, s26, 8
  s_add_u32 s25, s25, s28
  s_add_u32 s25, s25, 0
  v_xor_b32 v9, s26, v8
  v_lshl_add_u32 v9, v9, 6, v7
  v_add_u32 v220, s25, v9
  s_add_u32 s25, s24, 1
  s_and_b32 s26, s25, 3
  s_lshr_b32 s25, s25, 2
  s_mul_i32 s25, s25, 1056
  s_lshl_b32 s28, s26, 8
  s_add_u32 s25, s25, s28
  s_add_u32 s25, s25, 0
  v_xor_b32 v9, s26, v8
  v_lshl_add_u32 v9, v9, 6, v7
  v_add_u32 v221, s25, v9
  s_add_u32 s25, s24, 2
  s_and_b32 s26, s25, 3
  s_lshr_b32 s25, s25, 2
  s_mul_i32 s25, s25, 1056
  s_lshl_b32 s28, s26, 8
  s_add_u32 s25, s25, s28
  s_add_u32 s25, s25, 0
  v_xor_b32 v9, s26, v8
  v_lshl_add_u32 v9, v9, 6, v7
  v_add_u32 v222, s25, v9
  s_add_u32 s25, s24, 3
  s_and_b32 s26, s25, 3
  s_lshr_b32 s25, s25, 2
  s_mul_i32 s25, s25, 1056
  s_lshl_b32 s28, s26, 8
  s_add_u32 s25, s25, s28
  s_add_u32 s25, s25, 0
  v_xor_b32 v9, s26, v8
  v_lshl_add_u32 v9, v9, 6, v7
  v_add_u32 v223, s25, v9
  s_waitcnt vmcnt(0)
  s_mov_b64 exec, 1
  v_mov_b32 v234, 1
  ds_add_u32 v255, v234 offset:0
  s_mov_b64 exec, -1
  s_mov_b32 s100, 0
L_poll_1:
  ds_read_b32 v234, v255 offset:0
  s_waitcnt lgkmcnt(0)
  v_readfirstlane_b32 s27, v234
  s_cmp_ge_u32 s27, 4
  s_cbranch_scc1 L_go_2
  s_add_u32 s100, s100, 1
  s_cmp_ge_u32 s100, 200000
  s_cbranch_scc1 L_go_2
  s_sleep 1
  s_branch L_poll_1
L_go_2:
  ds_read_b64_tr_b16 v[0:1], v230 offset:0
  ds_read_b64_tr_b16 v[2:3], v230 offset:1024
  ds_read_b64_tr_b16 v[4:5], v231 offset:0
  ds_read_b64_tr_b16 v[6:7], v231 offset:1024
  ds_read_b64_tr_b16 v[8:9], v230 offset:8192
  ds_read_b64_tr_b16 v[10:11], v230 offset:9216
  ds_read_b64_tr_b16 v[12:13], v231 offset:8192
  ds_read_b64_tr_b16 v[14:15], v231 offset:9216
  ds_read_b64_tr_b16 v[16:17], v230 offset:16384
  ds_read_b64_tr_b16 v[18:19], v230 offset:17408
  ds_read_b64_tr_b16 v[20:21], v231 offset:16384
  ds_read_b64_tr_b16 v[22:23], v231 offset:17408
  s_waitcnt lgkmcnt(4)
  ds_read_b64_tr_b16 v[24:25], v230 offset:24576
  ds_read_b64_tr_b16 v[26:27], v230 offset:25600
  ds_read_b64_tr_b16 v[28:29], v231 offset:24576
  ds_read_b64_tr_b16 v[30:31], v231 offset:25600
  ds_read_b64_tr_b16 v[32:33], v230 offset:32768
  ds_read_b64_tr_b16 v[34:35], v230 offset:33792
  ds_read_b64_tr_b16 v[36:37], v231 offset:32768
  ds_read_b64_tr_b16 v[38:39], v231 offset:33792
  s_waitcnt lgkmcnt(4)
  ds_read_b64_tr_b16 v[40:41], v230 offset:40960
  ds_read_b64_tr_b16 v[42:43], v230 offset:41984
  ds_read_b64_tr_b16 v[44:45], v231 offset:40960
  ds_read_b64_tr_b16 v[46:47], v231 offset:41984
  ds_read_b64_tr_b16 v[48:49], v230 offset:49152
  ds_read_b64_tr_b16 v[50:51], v230 offset:50176
  ds_read_b64_tr_b16 v[52:53], v231 offset:49152
  ds_read_b64_tr_b16 v[54:55], v231 offset:50176
  s_waitcnt lgkmcnt(4)
  ds_read_b64_tr_b16 v[56:57], v230 offset:57344
  ds_read_b64_tr_b16 v[58:59], v230 offset:58368
  ds_read_b64_tr_b16 v[60:61], v231 offset:57344
  ds_read_b64_tr_b16 v[62:63], v231 offset:58368
  v_add_u32 v230, 0x10000, v230
  v_add_u32 v231, 0x10000, v231
  ds_read_b64_tr_b16 v[64:65], v230 offset:0
  ds_read_b64_tr_b16 v[66:67], v230 offset:1024
  ds_read_b64_tr_b16 v[68:69], v231 offset:0
  ds_read_b64_tr_b16 v[70:71], v231 offset:1024
  s_waitcnt lgkmcnt(4)
  ds_read_b64_tr_b16 v[72:73], v230 offset:8192
  ds_read_b64_tr_b16 v[74:75], v230 offset:9216
  ds_read_b64_tr_b16 v[76:77], v231 offset:8192
  ds_read_b64_tr_b16 v[78:79], v231 offset:9216
  ds_read_b64_tr_b16 v[80:81], v230 offset:16384
  ds_read_b64_tr_b16 v[82:83], v230 offset:17408
  ds_read_b64_tr_b16 v[84:85], v231 offset:16384
  ds_read_b64_tr_b16 v[86:87], v231 offset:17408
  s_waitcnt lgkmcnt(4)
  ds_read_b64_tr_b16 v[88:89], v230 offset:24576
  ds_read_b64_tr_b16 v[90:91], v230 offset:25600
  ds_read_b64_tr_b16 v[92:93], v231 offset:24576
  ds_read_b64_tr_b16 v[94:95], v231 offset:25600
  ds_read_b64_tr_b16 v[96:97], v230 offset:32768
  ds_read_b64_tr_b16 v[98:99], v230 offset:33792
  ds_read_b64_tr_b16 v[100:101], v231 offset:32768
  ds_read_b64_tr_b16 v[102:103], v231 offset:33792
  s_waitcnt lgkmcnt(4)
  s_waitcnt lgkmcnt(0)
  v_subrev_u32 v230, 65536, v230
  v_subrev_u32 v231, 65536, v231
  s_mov_b64 exec, 1
  v_mov_b32 v234, 1
  ds_add_u32 v255, v234 offset:0
  s_mov_b64 exec, -1
  s_mov_b32 s100, 0
L_poll_3:
  ds_read_b32 v234, v255 offset:0
  s_waitcnt lgkmcnt(0)
  v_readfirstlane_b32 s27, v234
  s_cmp_ge_u32 s27, 8
  s_cbranch_scc1 L_go_4
  s_add_u32 s100, s100, 1
  s_cmp_ge_u32 s100, 200000
  s_cbranch_scc1 L_go_4
  s_sleep 1
  s_branch L_poll_3
L_go_4:
  s_mul_i32 s32, s31, 12
  s_lshr_b32 s32, s32, 3
  s_lshl_b32 s28, s32, 13
  s_add_u32 s30, s28, 0
  s_add_u32 m0, s30, s88
  s_add_u32 s30, s28, 106496
  s_add_u32 s30, s30, s29
  buffer_load_dwordx4 v228, s[12:15], s30 offen lds
  buffer_load_dwordx4 v228, s[12:15], s30 offen offset:1024 lds
  s_add_u32 s32, s32, 1
  s_cmp_eq_u32 s32, 12
  s_cselect_b32 s32, 0, s32
  s_lshl_b32 s28, s32, 13
  s_add_u32 s30, s28, 0
  s_add_u32 m0, s30, s88
  s_add_u32 s30, s28, 106496
  s_add_u32 s30, s30, s29
  buffer_load_dwordx4 v228, s[12:15], s30 offen lds
  buffer_load_dwordx4 v228, s[12:15], s30 offen offset:1024 lds
  s_add_u32 s32, s32, 1
  s_cmp_eq_u32 s32, 12
  s_cselect_b32 s32, 0, s32
  s_lshl_b32 s28, s32, 13
  s_add_u32 s30, s28, 0
  s_add_u32 m0, s30, s88
  s_add_u32 s30, s28, 106496
  s_add_u32 s30, s30, s29
  buffer_load_dwordx4 v228, s[12:15], s30 offen lds
  buffer_load_dwordx4 v228, s[12:15], s30 offen offset:1024 lds
  s_add_u32 s32, s32, 1
  s_cmp_eq_u32 s32, 12
  s_cselect_b32 s32, 0, s32
  s_lshl_b32 s28, s32, 13
  s_add_u32 s30, s28, 0
  s_add_u32 m0, s30, s88
  s_add_u32 s30, s28, 106496
  s_add_u32 s30, s30, s29
  buffer_load_dwordx4 v228, s[12:15], s30 offen lds
  buffer_load_dwordx4 v228, s[12:15], s30 offen offset:1024 lds
  s_add_u32 s32, s32, 1
  s_cmp_eq_u32 s32, 12
  s_cselect_b32 s32, 0, s32
  s_lshl_b32 s28, s32, 13
  s_add_u32 s30, s28, 0
  s_add_u32 m0, s30, s88
  s_add_u32 s30, s28, 106496
  s_add_u32 s30, s30, s29
  buffer_load_dwordx4 v228, s[12:15], s30 offen lds
  buffer_load_dwordx4 v228, s[12:15], s30 offen offset:1024 lds
  s_add_u32 s32, s32, 1
  s_cmp_eq_u32 s32, 12
  s_cselect_b32 s32, 0, s32
  s_lshl_b32 s28, s32, 13
  s_add_u32 s30, s28, 0
  s_add_u32 m0, s30, s88
  s_add_u32 s30, s28, 106496
  s_add_u32 s30, s30, s29
  buffer_load_dwordx4 v228, s[12:15], s30 offen lds
  buffer_load_dwordx4 v228, s[12:15], s30 offen offset:1024 lds
  s_add_u32 s32, s32, 1
  s_cmp_eq_u32 s32, 12
  s_cselect_b32 s32, 0, s32
  s_lshl_b32 s28, s32, 13
  s_add_u32 s30, s28, 0
  s_add_u32 m0, s30, s88
  s_add_u32 s30, s28, 106496
  s_add_u32 s30, s30, s29
  buffer_load_dwordx4 v228, s[12:15], s30 offen lds
  buffer_load_dwordx4 v228, s[12:15], s30 offen offset:1024 lds
  s_add_u32 s32, s32, 1
  s_cmp_eq_u32 s32, 12
  s_cselect_b32 s32, 0, s32
  s_lshl_b32 s28, s32, 13
  s_add_u32 s30, s28, 0
  s_add_u32 m0, s30, s88
  s_add_u32 s30, s28, 106496
  s_add_u32 s30, s30, s29
  buffer_load_dwordx4 v228, s[12:15], s30 offen lds
  buffer_load_dwordx4 v228, s[12:15], s30 offen offset:1024 lds
  s_add_u32 s32, s32, 1
  s_cmp_eq_u32 s32, 12
  s_cselect_b32 s32, 0, s32
  s_lshl_b32 s28, s32, 13
  s_add_u32 s30, s28, 0
  s_add_u32 m0, s30, s88
  s_add_u32 s30, s28, 106496
  s_add_u32 s30, s30, s29
  buffer_load_dwordx4 v228, s[12:15], s30 offen lds
  buffer_load_dwordx4 v228, s[12:15], s30 offen offset:1024 lds
  s_add_u32 s32, s32, 1
  s_cmp_eq_u32 s32, 12
  s_cselect_b32 s32, 0, s32
  s_lshl_b32 s28, s32, 13
  s_add_u32 s30, s28, 0
  s_add_u32 m0, s30, s88
  s_add_u32 s30, s28, 106496
  s_add_u32 s30, s30, s29
  buffer_load_dwordx4 v228, s[12:15], s30 offen lds
  buffer_load_dwordx4 v228, s[12:15], s30 offen offset:1024 lds
  s_add_u32 s32, s32, 1
  s_cmp_eq_u32 s32, 12
  s_cselect_b32 s32, 0, s32
  s_lshl_b32 s28, s32, 13
  s_add_u32 s30, s28, 0
  s_add_u32 m0, s30, s88
  s_add_u32 s30, s28, 106496
  s_add_u32 s30, s30, s29
  buffer_load_dwordx4 v228, s[12:15], s30 offen lds
  buffer_load_dwordx4 v228, s[12:15], s30 offen offset:1024 lds
  s_add_u32 s32, s32, 1
  s_cmp_eq_u32 s32, 12
  s_cselect_b32 s32, 0, s32
  s_lshl_b32 s28, s32, 13
  s_add_u32 s30, s28, 0
  s_add_u32 m0, s30, s88
  s_add_u32 s30, s28, 106496
  s_add_u32 s30, s30, s29
  buffer_load_dwordx4 v228, s[12:15], s30 offen lds
  buffer_load_dwordx4 v228, s[12:15], s30 offen offset:1024 lds
  s_waitcnt vmcnt(0)
  s_mov_b64 exec, 1
  v_mov_b32 v234, 1
  ds_add_u32 v255, v234 offset:0
  s_mov_b64 exec, -1
  s_mov_b32 s100, 0
L_poll_5:
  ds_read_b32 v234, v255 offset:0
  s_waitcnt lgkmcnt(0)
  v_readfirstlane_b32 s27, v234
  s_cmp_ge_u32 s27, 12
  s_cbranch_scc1 L_go_6
  s_add_u32 s100, s100, 1
  s_cmp_ge_u32 s100, 200000
  s_cbranch_scc1 L_go_6
  s_sleep 1
  s_branch L_poll_5
L_go_6:
  ds_read_b64_tr_b16 v[104:105], v230 offset:0
  ds_read_b64_tr_b16 v[106:107], v230 offset:1024
  ds_read_b64_tr_b16 v[108:109], v231 offset:0
  ds_read_b64_tr_b16 v[110:111], v231 offset:1024
  ds_read_b64_tr_b16 v[112:113], v230 offset:8192
  ds_read_b64_tr_b16 v[114:115], v230 offset:9216
  ds_read_b64_tr_b16 v[116:117], v231 offset:8192
  ds_read_b64_tr_b16 v[118:119], v231 offset:9216
  ds_read_b64_tr_b16 v[120:121], v230 offset:16384
  ds_read_b64_tr_b16 v[122:123], v230 offset:17408
  ds_read_b64_tr_b16 v[124:125], v231 offset:16384
  ds_read_b64_tr_b16 v[126:127], v231 offset:17408
  s_waitcnt lgkmcnt(4)
  ds_read_b64_tr_b16 v[128:129], v230 offset:24576
  ds_read_b64_tr_b16 v[130:131], v230 offset:25600
  ds_read_b64_tr_b16 v[132:133], v231 offset:24576
  ds_read_b64_tr_b16 v[134:135], v231 offset:25600
  ds_read_b64_tr_b16 v[136:137], v230 offset:32768
  ds_read_b64_tr_b16 v[138:139], v230 offset:33792
  ds_read_b64_tr_b16 v[140:141], v231 offset:32768
  ds_read_b64_tr_b16 v[142:143], v231 offset:33792
  s_waitcnt lgkmcnt(4)
  ds_read_b64_tr_b16 v[144:145], v230 offset:40960
  ds_read_b64_tr_b16 v[146:147], v230 offset:41984
  ds_read_b64_tr_b16 v[148:149], v231 offset:40960
  ds_read_b64_tr_b16 v[150:151], v231 offset:41984
  ds_read_b64_tr_b16 v[152:153], v230 offset:49152
  ds_read_b64_tr_b16 v[154:155], v230 offset:50176
  ds_read_b64_tr_b16 v[156:157], v231 offset:49152
  ds_read_b64_tr_b16 v[158:159], v231 offset:50176
  s_waitcnt lgkmcnt(4)
  ds_read_b64_tr_b16 v[160:161], v230 offset:57344
  ds_read_b64_tr_b16 v[162:163], v230 offset:58368
  ds_read_b64_tr_b16 v[164:165], v231 offset:57344
  ds_read_b64_tr_b16 v[166:167], v231 offset:58368
  v_add_u32 v230, 0x10000, v230
  v_add_u32 v231, 0x10000, v231
  ds_read_b64_tr_b16 v[168:169], v230 offset:0
  ds_read_b64_tr_b16 v[170:171], v230 offset:1024
  ds_read_b64_tr_b16 v[172:173], v231 offset:0
  ds_read_b64_tr_b16 v[174:175], v231 offset:1024
  s_waitcnt lgkmcnt(4)
  ds_read_b64_tr_b16 v[176:177], v230 offset:8192
  ds_read_b64_tr_b16 v[178:179], v230 offset:9216
  ds_read_b64_tr_b16 v[180:181], v231 offset:8192
  ds_read_b64_tr_b16 v[182:183], v231 offset:9216
  ds_read_b64_tr_b16 v[184:185], v230 offset:16384
  ds_read_b64_tr_b16 v[186:187], v230 offset:17408
  ds_read_b64_tr_b16 v[188:189], v231 offset:16384
  ds_read_b64_tr_b16 v[190:191], v231 offset:17408
  s_waitcnt lgkmcnt(4)
  ds_read_b64_tr_b16 v[192:193], v230 offset:24576
  ds_read_b64_tr_b16 v[194:195], v230 offset:25600
  ds_read_b64_tr_b16 v[196:197], v231 offset:24576
  ds_read_b64_tr_b16 v[198:199], v231 offset:25600
  s_waitcnt lgkmcnt(0)
  v_subrev_u32 v230, 65536, v230
  v_subrev_u32 v231, 65536, v231
  s_mov_b64 exec, 1
  v_mov_b32 v234, 1
  ds_add_u32 v255, v234 offset:0
  s_mov_b64 exec, -1
  s_mov_b32 s100, 0
L_poll_7:
  ds_read_b32 v234, v255 offset:12
  s_waitcnt lgkmcnt(0)
  v_readfirstlane_b32 s27, v234
  s_cmp_ge_u32 s27, 4
  s_cbranch_scc1 L_go_8
  s_add_u32 s100, s100, 1
  s_cmp_ge_u32 s100, 200000
  s_cbranch_scc1 L_go_8
  s_sleep 1
  s_branch L_poll_7
L_go_8:
  v_mov_b32 v200, 0
  v_mov_b32 v201, 0
  v_mov_b32 v202, 0
  v_mov_b32 v203, 0
  v_mov_b32 v204, 0
  v_mov_b32 v205, 0
  v_mov_b32 v206, 0
  v_mov_b32 v207, 0
  v_add_u32 v235, 106496, v233
  ds_read_b128 v[208:211], v235 offset:0
  ds_read_b128 v[212:215], v235 offset:1056
  ds_read_b128 v[216:219], v235 offset:2112
  s_waitcnt lgkmcnt(2)
  v_mfma_f32_16x16x32_bf16 v[200:203], v[208:211], v[0:3], v[200:203]
  v_mfma_f32_16x16x32_bf16 v[204:207], v[208:211], v[4:7], v[204:207]
  ds_read_b128 v[208:211], v235 offset:3168
  s_waitcnt lgkmcnt(2)
  v_mfma_f32_16x16x32_bf16 v[200:203], v[212:215], v[8:11], v[200:203]
  v_mfma_f32_16x16x32_bf16 v[204:207], v[212:215], v[12:15], v[204:207]
  ds_read_b128 v[212:215], v235 offset:4224
  s_waitcnt lgkmcnt(2)
  v_mfma_f32_16x16x32_bf16 v[200:203], v[216:219], v[16:19], v[200:203]
  v_mfma_f32_16x16x32_bf16 v[204:207], v[216:219], v[20:23], v[204:207]
  ds_read_b128 v[216:219], v235 offset:5280
  s_waitcnt lgkmcnt(2)
  v_mfma_f32_16x16x32_bf16 v[200:203], v[208:211], v[24:27], v[200:203]
  v_mfma_f32_16x16x32_bf16 v[204:207], v[208:211], v[28:31], v[204:207]
  ds_read_b128 v[208:211], v235 offset:6336
  s_waitcnt lgkmcnt(2)
  v_mfma_f32_16x16x32_bf16 v[200:203], v[212:215], v[32:35], v[200:203]
  v_mfma_f32_16x16x32_bf16 v[204:207], v[212:215], v[36:39], v[204:207]
  ds_read_b128 v[212:215], v235 offset:7392
  s_waitcnt lgkmcnt(2)
  v_mfma_f32_16x16x32_bf16 v[200:203], v[216:219], v[40:43], v[200:203]
  v_mfma_f32_16x16x32_bf16 v[204:207], v[216:219], v[44:47], v[204:207]
  ds_read_b128 v[216:219], v235 offset:8448
  s_waitcnt lgkmcnt(2)
  v_mfma_f32_16x16x32_bf16 v[200:203], v[208:211], v[48:51], v[200:203]
  v_mfma_f32_16x16x32_bf16 v[204:207], v[208:211], v[52:55], v[204:207]
  ds_read_b128 v[208:211], v235 offset:9504
  s_waitcnt lgkmcnt(2)
  v_mfma_f32_16x16x32_bf16 v[200:203], v[212:215], v[56:59], v[200:203]
  v_mfma_f32_16x16x32_bf16 v[204:207], v[212:215], v[60:63], v[204:207]
  ds_read_b128 v[212:215], v235 offset:10560
  s_waitcnt lgkmcnt(2)
  v_mfma_f32_16x16x32_bf16 v[200:203], v[216:219], v[64:67], v[200:203]
  v_mfma_f32_16x16x32_bf16 v[204:207], v[216:219], v[68:71], v[204:207]
  ds_read_b128 v[216:219], v235 offset:11616
  s_waitcnt lgkmcnt(2)
  v_mfma_f32_16x16x32_bf16 v[200:203], v[208:211], v[72:75], v[200:203]
  v_mfma_f32_16x16x32_bf16 v[204:207], v[208:211], v[76:79], v[204:207]
  ds_read_b128 v[208:211], v235 offset:12672
  s_waitcnt lgkmcnt(2)
  v_mfma_f32_16x16x32_bf16 v[200:203], v[212:215], v[80:83], v[200:203]
  v_mfma_f32_16x16x32_bf16 v[204:207], v[212:215], v[84:87], v[204:207]
  ds_read_b128 v[212:215], v235 offset:13728
  s_waitcnt lgkmcnt(2)
  v_mfma_f32_16x16x32_bf16 v[200:203], v[216:219], v[88:91], v[200:203]
  v_mfma_f32_16x16x32_bf16 v[204:207], v[216:219], v[92:95], v[204:207]
  ds_read_b128 v[216:219], v235 offset:14784
  s_waitcnt lgkmcnt(2)
  v_mfma_f32_16x16x32_bf16 v[200:203], v[208:211], v[96:99], v[200:203]
  v_mfma_f32_16x16x32_bf16 v[204:207], v[208:211], v[100:103], v[204:207]
  ds_read_b128 v[208:211], v235 offset:15840
  s_waitcnt lgkmcnt(2)
  v_mfma_f32_16x16x32_bf16 v[200:203], v[212:215], v[104:107], v[200:203]
  v_mfma_f32_16x16x32_bf16 v[204:207], v[212:215], v[108:111], v[204:207]
  ds_read_b128 v[212:215], v235 offset:16896
  s_waitcnt lgkmcnt(2)
  v_mfma_f32_16x16x32_bf16 v[200:203], v[216:219], v[112:115], v[200:203]
  v_mfma_f32_16x16x32_bf16 v[204:207], v[216:219], v[116:119], v[204:207]
  ds_read_b128 v[216:219], v235 offset:17952
  s_waitcnt lgkmcnt(2)
  v_mfma_f32_16x16x32_bf16 v[200:203], v[208:211], v[120:123], v[200:203]
  v_mfma_f32_16x16x32_bf16 v[204:207], v[208:211], v[124:127], v[204:207]
  ds_read_b128 v[208:211], v235 offset:19008
  s_waitcnt lgkmcnt(2)
  v_mfma_f32_16x16x32_bf16 v[200:203], v[212:215], v[128:131], v[200:203]
  v_mfma_f32_16x16x32_bf16 v[204:207], v[212:215], v[132:135], v[204:207]
  ds_read_b128 v[212:215], v235 offset:20064
  s_waitcnt lgkmcnt(2)
  v_mfma_f32_16x16x32_bf16 v[200:203], v[216:219], v[136:139], v[200:203]
  v_mfma_f32_16x16x32_bf16 v[204:207], v[216:219], v[140:143], v[204:207]
  ds_read_b128 v[216:219], v235 offset:21120
  s_waitcnt lgkmcnt(2)
  v_mfma_f32_16x16x32_bf16 v[200:203], v[208:211], v[144:147], v[200:203]
  v_mfma_f32_16x16x32_bf16 v[204:207], v[208:211], v[148:151], v[204:207]
  ds_read_b128 v[208:211], v235 offset:22176
  s_waitcnt lgkmcnt(2)
  v_mfma_f32_16x16x32_bf16 v[200:203], v[212:215], v[152:155], v[200:203]
  v_mfma_f32_16x16x32_bf16 v[204:207], v[212:215], v[156:159], v[204:207]
  ds_read_b128 v[212:215], v235 offset:23232
  s_waitcnt lgkmcnt(2)
  v_mfma_f32_16x16x32_bf16 v[200:203], v[216:219], v[160:163], v[200:203]
  v_mfma_f32_16x16x32_bf16 v[204:207], v[216:219], v[164:167], v[204:207]
  ds_read_b128 v[216:219], v235 offset:24288
  s_waitcnt lgkmcnt(2)
  v_mfma_f32_16x16x32_bf16 v[200:203], v[208:211], v[168:171], v[200:203]
  v_mfma_f32_16x16x32_bf16 v[204:207], v[208:211], v[172:175], v[204:207]
  ds_read_b128 v[208:211], v235 offset:25344
  s_waitcnt lgkmcnt(2)
  v_mfma_f32_16x16x32_bf16 v[200:203], v[212:215], v[176:179], v[200:203]
  v_mfma_f32_16x16x32_bf16 v[204:207], v[212:215], v[180:183], v[204:207]
  s_waitcnt lgkmcnt(1)
  v_mfma_f32_16x16x32_bf16 v[200:203], v[216:219], v[184:187], v[200:203]
  v_mfma_f32_16x16x32_bf16 v[204:207], v[216:219], v[188:191], v[204:207]
  s_waitcnt lgkmcnt(0)
  v_mfma_f32_16x16x32_bf16 v[200:203], v[208:211], v[192:195], v[200:203]
  v_mfma_f32_16x16x32_bf16 v[204:207], v[208:211], v[196:199], v[204:207]
  s_mov_b64 exec, 1
  v_mov_b32 v234, 1
  ds_add_u32 v255, v234 offset:16
  s_mov_b64 exec, -1
  s_add_u32 s24, s35, 1
  s_and_b32 s24, s24, 3
  s_lshl_b32 s25, s34, 2
  s_add_u32 s24, s24, s25
  s_lshl_b32 s25, s24, 2
  s_add_u32 s26, s25, s35
  s_lshl_b32 s26, s26, 2
  s_add_u32 s26, s26, s33
  s_lshl_b32 s26, s26, 11
  s_add_u32 s26, s26, 0
  s_add_u32 s98, s90, s26
  s_addc_u32 s99, s91, 0
  v_cvt_pk_bf16_f32 v244, v200, v201
  v_cvt_pk_bf16_f32 v245, v202, v203
  v_cvt_pk_bf16_f32 v246, v204, v205
  v_cvt_pk_bf16_f32 v247, v206, v207
  global_store_dwordx4 v240, v[244:247], s[98:99] sc0 sc1
  s_nop 1
  s_mov_b32 s100, 0
L_poll_9:
  ds_read_b32 v234, v255 offset:32
  s_waitcnt lgkmcnt(0)
  v_readfirstlane_b32 s27, v234
  s_cmp_ge_u32 s27, 4
  s_cbranch_scc1 L_go_10
  s_add_u32 s100, s100, 1
  s_cmp_ge_u32 s100, 200000
  s_cbranch_scc1 L_go_10
  s_sleep 1
  s_branch L_poll_9
L_go_10:
  v_mov_b32 v200, 0
  v_mov_b32 v201, 0
  v_mov_b32 v202, 0
  v_mov_b32 v203, 0
  v_mov_b32 v204, 0
  v_mov_b32 v205, 0
  v_mov_b32 v206, 0
  v_mov_b32 v207, 0
  v_add_u32 v235, 132896, v233
  ds_read_b128 v[208:211], v235 offset:0
  ds_read_b128 v[212:215], v235 offset:1056
  ds_read_b128 v[216:219], v235 offset:2112
  s_waitcnt lgkmcnt(2)
  v_mfma_f32_16x16x32_bf16 v[200:203], v[208:211], v[0:3], v[200:203]
  v_mfma_f32_16x16x32_bf16 v[204:207], v[208:211], v[4:7], v[204:207]
  ds_read_b128 v[208:211], v235 offset:3168
  s_waitcnt lgkmcnt(2)
  v_mfma_f32_16x16x32_bf16 v[200:203], v[212:215], v[8:11], v[200:203]
  v_mfma_f32_16x16x32_bf16 v[204:207], v[212:215], v[12:15], v[204:207]
  ds_read_b128 v[212:215], v235 offset:4224
  s_waitcnt lgkmcnt(2)
  v_mfma_f32_16x16x32_bf16 v[200:203], v[216:219], v[16:19], v[200:203]
  v_mfma_f32_16x16x32_bf16 v[204:207], v[216:219], v[20:23], v[204:207]
  ds_read_b128 v[216:219], v235 offset:5280
  s_waitcnt lgkmcnt(2)
  v_mfma_f32_16x16x32_bf16 v[200:203], v[208:211], v[24:27], v[200:203]
  v_mfma_f32_16x16x32_bf16 v[204:207], v[208:211], v[28:31], v[204:207]
  ds_read_b128 v[208:211], v235 offset:6336
  s_waitcnt lgkmcnt(2)
  v_mfma_f32_16x16x32_bf16 v[200:203], v[212:215], v[32:35], v[200:203]
  v_mfma_f32_16x16x32_bf16 v[204:207], v[212:215], v[36:39], v[204:207]
  ds_read_b128 v[212:215], v235 offset:7392
  s_waitcnt lgkmcnt(2)
  v_mfma_f32_16x16x32_bf16 v[200:203], v[216:219], v[40:43], v[200:203]
  v_mfma_f32_16x16x32_bf16 v[204:207], v[216:219], v[44:47], v[204:207]
  ds_read_b128 v[216:219], v235 offset:8448
  s_waitcnt lgkmcnt(2)
  v_mfma_f32_16x16x32_bf16 v[200:203], v[208:211], v[48:51], v[200:203]
  v_mfma_f32_16x16x32_bf16 v[204:207], v[208:211], v[52:55], v[204:207]
  ds_read_b128 v[208:211], v235 offset:9504
  s_waitcnt lgkmcnt(2)
  v_mfma_f32_16x16x32_bf16 v[200:203], v[212:215], v[56:59], v[200:203]
  v_mfma_f32_16x16x32_bf16 v[204:207], v[212:215], v[60:63], v[204:207]
  ds_read_b128 v[212:215], v235 offset:10560
  s_waitcnt lgkmcnt(2)
  v_mfma_f32_16x16x32_bf16 v[200:203], v[216:219], v[64:67], v[200:203]
  v_mfma_f32_16x16x32_bf16 v[204:207], v[216:219], v[68:71], v[204:207]
  ds_read_b128 v[216:219], v235 offset:11616
  s_waitcnt lgkmcnt(2)
  v_mfma_f32_16x16x32_bf16 v[200:203], v[208:211], v[72:75], v[200:203]
  v_mfma_f32_16x16x32_bf16 v[204:207], v[208:211], v[76:79], v[204:207]
  ds_read_b128 v[208:211], v235 offset:12672
  s_waitcnt lgkmcnt(2)
  v_mfma_f32_16x16x32_bf16 v[200:203], v[212:215], v[80:83], v[200:203]
  v_mfma_f32_16x16x32_bf16 v[204:207], v[212:215], v[84:87], v[204:207]
  ds_read_b128 v[212:215], v235 offset:13728
  s_waitcnt lgkmcnt(2)
  v_mfma_f32_16x16x32_bf16 v[200:203], v[216:219], v[88:91], v[200:203]
  v_mfma_f32_16x16x32_bf16 v[204:207], v[216:219], v[92:95], v[204:207]
  ds_read_b128 v[216:219], v235 offset:14784
  s_waitcnt lgkmcnt(2)
  v_mfma_f32_16x16x32_bf16 v[200:203], v[208:211], v[96:99], v[200:203]
  v_mfma_f32_16x16x32_bf16 v[204:207], v[208:211], v[100:103], v[204:207]
  ds_read_b128 v[208:211], v235 offset:15840
  s_waitcnt lgkmcnt(2)
  v_mfma_f32_16x16x32_bf16 v[200:203], v[212:215], v[104:107], v[200:203]
  v_mfma_f32_16x16x32_bf16 v[204:207], v[212:215], v[108:111], v[204:207]
  ds_read_b128 v[212:215], v235 offset:16896
  s_waitcnt lgkmcnt(2)
  v_mfma_f32_16x16x32_bf16 v[200:203], v[216:219], v[112:115], v[200:203]
  v_mfma_f32_16x16x32_bf16 v[204:207], v[216:219], v[116:119], v[204:207]
  ds_read_b128 v[216:219], v235 offset:17952
  s_waitcnt lgkmcnt(2)
  v_mfma_f32_16x16x32_bf16 v[200:203], v[208:211], v[120:123], v[200:203]
  v_mfma_f32_16x16x32_bf16 v[204:207], v[208:211], v[124:127], v[204:207]
  ds_read_b128 v[208:211], v235 offset:19008
  s_waitcnt lgkmcnt(2)
  v_mfma_f32_16x16x32_bf16 v[200:203], v[212:215], v[128:131], v[200:203]
  v_mfma_f32_16x16x32_bf16 v[204:207], v[212:215], v[132:135], v[204:207]
  ds_read_b128 v[212:215], v235 offset:20064
  s_waitcnt lgkmcnt(2)
  v_mfma_f32_16x16x32_bf16 v[200:203], v[216:219], v[136:139], v[200:203]
  v_mfma_f32_16x16x32_bf16 v[204:207], v[216:219], v[140:143], v[204:207]
  ds_read_b128 v[216:219], v235 offset:21120
  s_waitcnt lgkmcnt(2)
  v_mfma_f32_16x16x32_bf16 v[200:203], v[208:211], v[144:147], v[200:203]
  v_mfma_f32_16x16x32_bf16 v[204:207], v[208:211], v[148:151], v[204:207]
  ds_read_b128 v[208:211], v235 offset:22176
  s_waitcnt lgkmcnt(2)
  v_mfma_f32_16x16x32_bf16 v[200:203], v[212:215], v[152:155], v[200:203]
  v_mfma_f32_16x16x32_bf16 v[204:207], v[212:215], v[156:159], v[204:207]
  ds_read_b128 v[212:215], v235 offset:23232
  s_waitcnt lgkmcnt(2)
  v_mfma_f32_16x16x32_bf16 v[200:203], v[216:219], v[160:163], v[200:203]
  v_mfma_f32_16x16x32_bf16 v[204:207], v[216:219], v[164:167], v[204:207]
  ds_read_b128 v[216:219], v235 offset:24288
  s_waitcnt lgkmcnt(2)
  v_mfma_f32_16x16x32_bf16 v[200:203], v[208:211], v[168:171], v[200:203]
  v_mfma_f32_16x16x32_bf16 v[204:207], v[208:211], v[172:175], v[204:207]
  ds_read_b128 v[208:211], v235 offset:25344
  s_waitcnt lgkmcnt(2)
  v_mfma_f32_16x16x32_bf16 v[200:203], v[212:215], v[176:179], v[200:203]
  v_mfma_f32_16x16x32_bf16 v[204:207], v[212:215], v[180:183], v[204:207]
  s_waitcnt lgkmcnt(1)
  v_mfma_f32_16x16x32_bf16 v[200:203], v[216:219], v[184:187], v[200:203]
  v_mfma_f32_16x16x32_bf16 v[204:207], v[216:219], v[188:191], v[204:207]
  s_waitcnt lgkmcnt(0)
  v_mfma_f32_16x16x32_bf16 v[200:203], v[208:211], v[192:195], v[200:203]
  v_mfma_f32_16x16x32_bf16 v[204:207], v[208:211], v[196:199], v[204:207]
  s_waitcnt vmcnt(0)
  s_add_u32 s24, s35, 1
  s_and_b32 s24, s24, 3
  s_lshl_b32 s25, s34, 2
  s_add_u32 s24, s24, s25
  s_lshl_b32 s25, s24, 2
  s_add_u32 s25, s25, s33
  s_lshl_b32 s25, s25, 7
  s_lshl_b32 s26, s35, 2
  s_add_u32 s25, s25, s26
  s_add_u32 s25, s25, 16777216
  s_add_u32 s96, s90, s25
  s_addc_u32 s97, s91, 0
  s_mov_b64 exec, 1
  v_mov_b32 v234, 0
  v_mov_b32 v241, s94
  global_store_dword v234, v241, s[96:97] sc0 sc1
  s_mov_b64 exec, -1
  s_add_u32 s24, s35, 2
  s_and_b32 s24, s24, 3
  s_lshl_b32 s25, s34, 2
  s_add_u32 s24, s24, s25
  s_lshl_b32 s25, s24, 2
  s_add_u32 s26, s25, s35
  s_lshl_b32 s26, s26, 2
  s_add_u32 s26, s26, s33
  s_lshl_b32 s26, s26, 11
  s_add_u32 s26, s26, 0
  s_add_u32 s98, s90, s26
  s_addc_u32 s99, s91, 0
  v_cvt_pk_bf16_f32 v244, v200, v201
  v_cvt_pk_bf16_f32 v245, v202, v203
  v_cvt_pk_bf16_f32 v246, v204, v205
  v_cvt_pk_bf16_f32 v247, v206, v207
  global_store_dwordx4 v240, v[244:247], s[98:99] sc0 sc1
  s_nop 1
  s_mov_b32 s100, 0
L_poll_11:
  ds_read_b32 v234, v255 offset:36
  s_waitcnt lgkmcnt(0)
  v_readfirstlane_b32 s27, v234
  s_cmp_ge_u32 s27, 4
  s_cbranch_scc1 L_go_12
  s_add_u32 s100, s100, 1
  s_cmp_ge_u32 s100, 200000
  s_cbranch_scc1 L_go_12
  s_sleep 1
  s_branch L_poll_11
L_go_12:
  v_mov_b32 v200, 0
  v_mov_b32 v201, 0
  v_mov_b32 v202, 0
  v_mov_b32 v203, 0
  v_mov_b32 v204, 0
  v_mov_b32 v205, 0
  v_mov_b32 v206, 0
  v_mov_b32 v207, 0
  v_add_u32 v235, 106496, v233
  ds_read_b128 v[208:211], v235 offset:0
  ds_read_b128 v[212:215], v235 offset:1056
  ds_read_b128 v[216:219], v235 offset:2112
  s_waitcnt lgkmcnt(2)
  v_mfma_f32_16x16x32_bf16 v[200:203], v[208:211], v[0:3], v[200:203]
  v_mfma_f32_16x16x32_bf16 v[204:207], v[208:211], v[4:7], v[204:207]
  ds_read_b128 v[208:211], v235 offset:3168
  s_waitcnt lgkmcnt(2)
  v_mfma_f32_16x16x32_bf16 v[200:203], v[212:215], v[8:11], v[200:203]
  v_mfma_f32_16x16x32_bf16 v[204:207], v[212:215], v[12:15], v[204:207]
  ds_read_b128 v[212:215], v235 offset:4224
  s_waitcnt lgkmcnt(2)
  v_mfma_f32_16x16x32_bf16 v[200:203], v[216:219], v[16:19], v[200:203]
  v_mfma_f32_16x16x32_bf16 v[204:207], v[216:219], v[20:23], v[204:207]
  ds_read_b128 v[216:219], v235 offset:5280
  s_waitcnt lgkmcnt(2)
  v_mfma_f32_16x16x32_bf16 v[200:203], v[208:211], v[24:27], v[200:203]
  v_mfma_f32_16x16x32_bf16 v[204:207], v[208:211], v[28:31], v[204:207]
  ds_read_b128 v[208:211], v235 offset:6336
  s_waitcnt lgkmcnt(2)
  v_mfma_f32_16x16x32_bf16 v[200:203], v[212:215], v[32:35], v[200:203]
  v_mfma_f32_16x16x32_bf16 v[204:207], v[212:215], v[36:39], v[204:207]
  ds_read_b128 v[212:215], v235 offset:7392
  s_waitcnt lgkmcnt(2)
  v_mfma_f32_16x16x32_bf16 v[200:203], v[216:219], v[40:43], v[200:203]
  v_mfma_f32_16x16x32_bf16 v[204:207], v[216:219], v[44:47], v[204:207]
  ds_read_b128 v[216:219], v235 offset:8448
  s_waitcnt lgkmcnt(2)
  v_mfma_f32_16x16x32_bf16 v[200:203], v[208:211], v[48:51], v[200:203]
  v_mfma_f32_16x16x32_bf16 v[204:207], v[208:211], v[52:55], v[204:207]
  ds_read_b128 v[208:211], v235 offset:9504
  s_waitcnt lgkmcnt(2)
  v_mfma_f32_16x16x32_bf16 v[200:203], v[212:215], v[56:59], v[200:203]
  v_mfma_f32_16x16x32_bf16 v[204:207], v[212:215], v[60:63], v[204:207]
  ds_read_b128 v[212:215], v235 offset:10560
  s_waitcnt lgkmcnt(2)
  v_mfma_f32_16x16x32_bf16 v[200:203], v[216:219], v[64:67], v[200:203]
  v_mfma_f32_16x16x32_bf16 v[204:207], v[216:219], v[68:71], v[204:207]
  ds_read_b128 v[216:219], v235 offset:11616
  s_waitcnt lgkmcnt(2)
  v_mfma_f32_16x16x32_bf16 v[200:203], v[208:211], v[72:75], v[200:203]
  v_mfma_f32_16x16x32_bf16 v[204:207], v[208:211], v[76:79], v[204:207]
  ds_read_b128 v[208:211], v235 offset:12672
  s_waitcnt lgkmcnt(2)
  v_mfma_f32_16x16x32_bf16 v[200:203], v[212:215], v[80:83], v[200:203]
  v_mfma_f32_16x16x32_bf16 v[204:207], v[212:215], v[84:87], v[204:207]
  ds_read_b128 v[212:215], v235 offset:13728
  s_waitcnt lgkmcnt(2)
  v_mfma_f32_16x16x32_bf16 v[200:203], v[216:219], v[88:91], v[200:203]
  v_mfma_f32_16x16x32_bf16 v[204:207], v[216:219], v[92:95], v[204:207]
  ds_read_b128 v[216:219], v235 offset:14784
  s_waitcnt lgkmcnt(2)
  v_mfma_f32_16x16x32_bf16 v[200:203], v[208:211], v[96:99], v[200:203]
  v_mfma_f32_16x16x32_bf16 v[204:207], v[208:211], v[100:103], v[204:207]
  ds_read_b128 v[208:211], v235 offset:15840
  s_waitcnt lgkmcnt(2)
  v_mfma_f32_16x16x32_bf16 v[200:203], v[212:215], v[104:107], v[200:203]
  v_mfma_f32_16x16x32_bf16 v[204:207], v[212:215], v[108:111], v[204:207]
  ds_read_b128 v[212:215], v235 offset:16896
  s_waitcnt lgkmcnt(2)
  v_mfma_f32_16x16x32_bf16 v[200:203], v[216:219], v[112:115], v[200:203]
  v_mfma_f32_16x16x32_bf16 v[204:207], v[216:219], v[116:119], v[204:207]
  ds_read_b128 v[216:219], v235 offset:17952
  s_waitcnt lgkmcnt(2)
  v_mfma_f32_16x16x32_bf16 v[200:203], v[208:211], v[120:123], v[200:203]
  v_mfma_f32_16x16x32_bf16 v[204:207], v[208:211], v[124:127], v[204:207]
  ds_read_b128 v[208:211], v235 offset:19008
  s_waitcnt lgkmcnt(2)
  v_mfma_f32_16x16x32_bf16 v[200:203], v[212:215], v[128:131], v[200:203]
  v_mfma_f32_16x16x32_bf16 v[204:207], v[212:215], v[132:135], v[204:207]
  ds_read_b128 v[212:215], v235 offset:20064
  s_waitcnt lgkmcnt(2)
  v_mfma_f32_16x16x32_bf16 v[200:203], v[216:219], v[136:139], v[200:203]
  v_mfma_f32_16x16x32_bf16 v[204:207], v[216:219], v[140:143], v[204:207]
  ds_read_b128 v[216:219], v235 offset:21120
  s_waitcnt lgkmcnt(2)
  v_mfma_f32_16x16x32_bf16 v[200:203], v[208:211], v[144:147], v[200:203]
  v_mfma_f32_16x16x32_bf16 v[204:207], v[208:211], v[148:151], v[204:207]
  ds_read_b128 v[208:211], v235 offset:22176
  s_waitcnt lgkmcnt(2)
  v_mfma_f32_16x16x32_bf16 v[200:203], v[212:215], v[152:155], v[200:203]
  v_mfma_f32_16x16x32_bf16 v[204:207], v[212:215], v[156:159], v[204:207]
  ds_read_b128 v[212:215], v235 offset:23232
  s_waitcnt lgkmcnt(2)
  v_mfma_f32_16x16x32_bf16 v[200:203], v[216:219], v[160:163], v[200:203]
  v_mfma_f32_16x16x32_bf16 v[204:207], v[216:219], v[164:167], v[204:207]
  ds_read_b128 v[216:219], v235 offset:24288
  s_waitcnt lgkmcnt(2)
  v_mfma_f32_16x16x32_bf16 v[200:203], v[208:211], v[168:171], v[200:203]
  v_mfma_f32_16x16x32_bf16 v[204:207], v[208:211], v[172:175], v[204:207]
  ds_read_b128 v[208:211], v235 offset:25344
  s_waitcnt lgkmcnt(2)
  v_mfma_f32_16x16x32_bf16 v[200:203], v[212:215], v[176:179], v[200:203]
  v_mfma_f32_16x16x32_bf16 v[204:207], v[212:215], v[180:183], v[204:207]
  s_waitcnt lgkmcnt(1)
  v_mfma_f32_16x16x32_bf16 v[200:203], v[216:219], v[184:187], v[200:203]
  v_mfma_f32_16x16x32_bf16 v[204:207], v[216:219], v[188:191], v[204:207]
  s_waitcnt lgkmcnt(0)
  v_mfma_f32_16x16x32_bf16 v[200:203], v[208:211], v[192:195], v[200:203]
  v_mfma_f32_16x16x32_bf16 v[204:207], v[208:211], v[196:199], v[204:207]
  s_waitcnt vmcnt(0)
  s_add_u32 s24, s35, 2
  s_and_b32 s24, s24, 3
  s_lshl_b32 s25, s34, 2
  s_add_u32 s24, s24, s25
  s_lshl_b32 s25, s24, 2
  s_add_u32 s25, s25, s33
  s_lshl_b32 s25, s25, 7
  s_lshl_b32 s26, s35, 2
  s_add_u32 s25, s25, s26
  s_add_u32 s25, s25, 16777216
  s_add_u32 s96, s90, s25
  s_addc_u32 s97, s91, 0
  s_mov_b64 exec, 1
  v_mov_b32 v234, 0
  v_mov_b32 v241, s94
  global_store_dword v234, v241, s[96:97] sc0 sc1
  s_mov_b64 exec, -1
  s_add_u32 s24, s35, 3
  s_and_b32 s24, s24, 3
  s_lshl_b32 s25, s34, 2
  s_add_u32 s24, s24, s25
  s_lshl_b32 s25, s24, 2
  s_add_u32 s26, s25, s35
  s_lshl_b32 s26, s26, 2
  s_add_u32 s26, s26, s33
  s_lshl_b32 s26, s26, 11
  s_add_u32 s26, s26, 0
  s_add_u32 s98, s90, s26
  s_addc_u32 s99, s91, 0
  v_cvt_pk_bf16_f32 v244, v200, v201
  v_cvt_pk_bf16_f32 v245, v202, v203
  v_cvt_pk_bf16_f32 v246, v204, v205
  v_cvt_pk_bf16_f32 v247, v206, v207
  global_store_dwordx4 v240, v[244:247], s[98:99] sc0 sc1
  s_nop 1
  s_waitcnt vmcnt(0)
  s_add_u32 s24, s35, 3
  s_and_b32 s24, s24, 3
  s_lshl_b32 s25, s34, 2
  s_add_u32 s24, s24, s25
  s_lshl_b32 s25, s24, 2
  s_add_u32 s25, s25, s33
  s_lshl_b32 s25, s25, 7
  s_lshl_b32 s26, s35, 2
  s_add_u32 s25, s25, s26
  s_add_u32 s25, s25, 16777216
  s_add_u32 s96, s90, s25
  s_addc_u32 s97, s91, 0
  s_mov_b64 exec, 1
  v_mov_b32 v234, 0
  v_mov_b32 v241, s94
  global_store_dword v234, v241, s[96:97] sc0 sc1
  s_mov_b64 exec, -1
  s_mov_b32 s100, 0
L_poll_13:
  ds_read_b32 v234, v255 offset:24
  s_waitcnt lgkmcnt(0)
  v_readfirstlane_b32 s27, v234
  s_cmp_ge_u32 s27, 4
  s_cbranch_scc1 L_go_14
  s_add_u32 s100, s100, 1
  s_cmp_ge_u32 s100, 200000
  s_cbranch_scc1 L_go_14
  s_sleep 1
  s_branch L_poll_13
L_go_14:
  s_lshl_b32 s24, s34, 2
  s_add_u32 s24, s24, s35
  s_lshl_b32 s24, s24, 2
  s_add_u32 s24, s24, s33
  s_lshl_b32 s24, s24, 7
  s_add_u32 s24, s24, 16777216
  s_add_u32 s96, s90, s24
  s_addc_u32 s97, s91, 0
  v_mov_b32 v234, 0
  global_load_dwordx4 v[248:251], v234, s[96:97] sc0 sc1
  v_mov_b32 v200, 0
  v_mov_b32 v201, 0
  v_mov_b32 v202, 0
  v_mov_b32 v203, 0
  v_mov_b32 v204, 0
  v_mov_b32 v205, 0
  v_mov_b32 v206, 0
  v_mov_b32 v207, 0
  ds_read_b128 v[208:211], v220 offset:0
  ds_read_b128 v[212:215], v221 offset:0
  ds_read_b128 v[216:219], v222 offset:0
  s_waitcnt lgkmcnt(2)
  v_mfma_f32_16x16x32_bf16 v[200:203], v[208:211], v[0:3], v[200:203]
  v_mfma_f32_16x16x32_bf16 v[204:207], v[208:211], v[4:7], v[204:207]
  ds_read_b128 v[208:211], v223 offset:0
  s_waitcnt lgkmcnt(2)
  v_mfma_f32_16x16x32_bf16 v[200:203], v[212:215], v[8:11], v[200:203]
  v_mfma_f32_16x16x32_bf16 v[204:207], v[212:215], v[12:15], v[204:207]
  ds_read_b128 v[212:215], v220 offset:1056
  s_waitcnt lgkmcnt(2)
  v_mfma_f32_16x16x32_bf16 v[200:203], v[216:219], v[16:19], v[200:203]
  v_mfma_f32_16x16x32_bf16 v[204:207], v[216:219], v[20:23], v[204:207]
  ds_read_b128 v[216:219], v221 offset:1056
  s_waitcnt lgkmcnt(2)
  v_mfma_f32_16x16x32_bf16 v[200:203], v[208:211], v[24:27], v[200:203]
  v_mfma_f32_16x16x32_bf16 v[204:207], v[208:211], v[28:31], v[204:207]
  ds_read_b128 v[208:211], v222 offset:1056
  s_waitcnt lgkmcnt(2)
  v_mfma_f32_16x16x32_bf16 v[200:203], v[212:215], v[32:35], v[200:203]
  v_mfma_f32_16x16x32_bf16 v[204:207], v[212:215], v[36:39], v[204:207]
  ds_read_b128 v[212:215], v223 offset:1056
  s_waitcnt lgkmcnt(2)
  v_mfma_f32_16x16x32_bf16 v[200:203], v[216:219], v[40:43], v[200:203]
  v_mfma_f32_16x16x32_bf16 v[204:207], v[216:219], v[44:47], v[204:207]
  ds_read_b128 v[216:219], v220 offset:2112
  s_waitcnt lgkmcnt(2)
  v_mfma_f32_16x16x32_bf16 v[200:203], v[208:211], v[48:51], v[200:203]
  v_mfma_f32_16x16x32_bf16 v[204:207], v[208:211], v[52:55], v[204:207]
  ds_read_b128 v[208:211], v221 offset:2112
  s_waitcnt lgkmcnt(2)
  v_mfma_f32_16x16x32_bf16 v[200:203], v[212:215], v[56:59], v[200:203]
  v_mfma_f32_16x16x32_bf16 v[204:207], v[212:215], v[60:63], v[204:207]
  ds_read_b128 v[212:215], v222 offset:2112
  s_waitcnt lgkmcnt(2)
  v_mfma_f32_16x16x32_bf16 v[200:203], v[216:219], v[64:67], v[200:203]
  v_mfma_f32_16x16x32_bf16 v[204:207], v[216:219], v[68:71], v[204:207]
  ds_read_b128 v[216:219], v223 offset:2112
  s_waitcnt lgkmcnt(2)
  v_mfma_f32_16x16x32_bf16 v[200:203], v[208:211], v[72:75], v[200:203]
  v_mfma_f32_16x16x32_bf16 v[204:207], v[208:211], v[76:79], v[204:207]
  ds_read_b128 v[208:211], v220 offset:3168
  s_waitcnt lgkmcnt(2)
  v_mfma_f32_16x16x32_bf16 v[200:203], v[212:215], v[80:83], v[200:203]
  v_mfma_f32_16x16x32_bf16 v[204:207], v[212:215], v[84:87], v[204:207]
  ds_read_b128 v[212:215], v221 offset:3168
  s_waitcnt lgkmcnt(2)
  v_mfma_f32_16x16x32_bf16 v[200:203], v[216:219], v[88:91], v[200:203]
  v_mfma_f32_16x16x32_bf16 v[204:207], v[216:219], v[92:95], v[204:207]
  ds_read_b128 v[216:219], v222 offset:3168
  s_waitcnt lgkmcnt(2)
  v_mfma_f32_16x16x32_bf16 v[200:203], v[208:211], v[96:99], v[200:203]
  v_mfma_f32_16x16x32_bf16 v[204:207], v[208:211], v[100:103], v[204:207]
  ds_read_b128 v[208:211], v223 offset:3168
  s_waitcnt lgkmcnt(2)
  v_mfma_f32_16x16x32_bf16 v[200:203], v[212:215], v[104:107], v[200:203]
  v_mfma_f32_16x16x32_bf16 v[204:207], v[212:215], v[108:111], v[204:207]
  ds_read_b128 v[212:215], v220 offset:4224
  s_waitcnt lgkmcnt(2)
  v_mfma_f32_16x16x32_bf16 v[200:203], v[216:219], v[112:115], v[200:203]
  v_mfma_f32_16x16x32_bf16 v[204:207], v[216:219], v[116:119], v[204:207]
  ds_read_b128 v[216:219], v221 offset:4224
  s_waitcnt lgkmcnt(2)
  v_mfma_f32_16x16x32_bf16 v[200:203], v[208:211], v[120:123], v[200:203]
  v_mfma_f32_16x16x32_bf16 v[204:207], v[208:211], v[124:127], v[204:207]
  ds_read_b128 v[208:211], v222 offset:4224
  s_waitcnt lgkmcnt(2)
  v_mfma_f32_16x16x32_bf16 v[200:203], v[212:215], v[128:131], v[200:203]
  v_mfma_f32_16x16x32_bf16 v[204:207], v[212:215], v[132:135], v[204:207]
  ds_read_b128 v[212:215], v223 offset:4224
  s_waitcnt lgkmcnt(2)
  v_mfma_f32_16x16x32_bf16 v[200:203], v[216:219], v[136:139], v[200:203]
  v_mfma_f32_16x16x32_bf16 v[204:207], v[216:219], v[140:143], v[204:207]
  ds_read_b128 v[216:219], v220 offset:5280
  s_waitcnt lgkmcnt(2)
  v_mfma_f32_16x16x32_bf16 v[200:203], v[208:211], v[144:147], v[200:203]
  v_mfma_f32_16x16x32_bf16 v[204:207], v[208:211], v[148:151], v[204:207]
  ds_read_b128 v[208:211], v221 offset:5280
  s_waitcnt lgkmcnt(2)
  v_mfma_f32_16x16x32_bf16 v[200:203], v[212:215], v[152:155], v[200:203]
  v_mfma_f32_16x16x32_bf16 v[204:207], v[212:215], v[156:159], v[204:207]
  ds_read_b128 v[212:215], v222 offset:5280
  s_waitcnt lgkmcnt(2)
  v_mfma_f32_16x16x32_bf16 v[200:203], v[216:219], v[160:163], v[200:203]
  v_mfma_f32_16x16x32_bf16 v[204:207], v[216:219], v[164:167], v[204:207]
  ds_read_b128 v[216:219], v223 offset:5280
  s_waitcnt lgkmcnt(2)
  v_mfma_f32_16x16x32_bf16 v[200:203], v[208:211], v[168:171], v[200:203]
  v_mfma_f32_16x16x32_bf16 v[204:207], v[208:211], v[172:175], v[204:207]
  ds_read_b128 v[208:211], v220 offset:6336
  s_waitcnt lgkmcnt(2)
  v_mfma_f32_16x16x32_bf16 v[200:203], v[212:215], v[176:179], v[200:203]
  v_mfma_f32_16x16x32_bf16 v[204:207], v[212:215], v[180:183], v[204:207]
  s_waitcnt lgkmcnt(1)
  v_mfma_f32_16x16x32_bf16 v[200:203], v[216:219], v[184:187], v[200:203]
  v_mfma_f32_16x16x32_bf16 v[204:207], v[216:219], v[188:191], v[204:207]
  s_waitcnt lgkmcnt(0)
  v_mfma_f32_16x16x32_bf16 v[200:203], v[208:211], v[192:195], v[200:203]
  v_mfma_f32_16x16x32_bf16 v[204:207], v[208:211], v[196:199], v[204:207]
  s_mov_b32 s25, 0
  v_mov_b32 v234, 0
  s_branch L_fchk
L_fpoll:
  global_load_dwordx4 v[248:251], v234, s[96:97] sc0 sc1
L_fchk:
  s_waitcnt vmcnt(0)
  s_mov_b32 s26, 0
  v_readfirstlane_b32 s27, v248
  s_cmp_eq_u32 s27, s94
  s_addc_u32 s26, s26, 0
  v_readfirstlane_b32 s27, v249
  s_cmp_eq_u32 s27, s94
  s_addc_u32 s26, s26, 0
  v_readfirstlane_b32 s27, v250
  s_cmp_eq_u32 s27, s94
  s_addc_u32 s26, s26, 0
  v_readfirstlane_b32 s27, v251
  s_cmp_eq_u32 s27, s94
  s_addc_u32 s26, s26, 0
  s_cmp_ge_u32 s26, 3
  s_cbranch_scc1 L_fgo
  s_add_u32 s25, s25, 1
  s_cmp_lt_u32 s25, 200000
  s_cbranch_scc0 L_fgo
  s_sleep 2
  s_branch L_fpoll
L_fgo:
  s_add_u32 s24, s35, 1
  s_and_b32 s24, s24, 3
  s_lshl_b32 s25, s34, 2
  s_add_u32 s25, s25, s35
  s_lshl_b32 s25, s25, 2
  s_add_u32 s25, s25, s24
  s_lshl_b32 s25, s25, 2
  s_add_u32 s25, s25, s33
  s_lshl_b32 s25, s25, 11
  s_add_u32 s25, s25, 0
  s_add_u32 s98, s90, s25
  s_addc_u32 s99, s91, 0
  global_load_dwordx4 v[224:227], v240, s[98:99] sc0 sc1
  s_add_u32 s24, s35, 2
  s_and_b32 s24, s24, 3
  s_lshl_b32 s25, s34, 2
  s_add_u32 s25, s25, s35
  s_lshl_b32 s25, s25, 2
  s_add_u32 s25, s25, s24
  s_lshl_b32 s25, s25, 2
  s_add_u32 s25, s25, s33
  s_lshl_b32 s25, s25, 11
  s_add_u32 s25, s25, 0
  s_add_u32 s98, s90, s25
  s_addc_u32 s99, s91, 0
  global_load_dwordx4 v[244:247], v240, s[98:99] sc0 sc1
  s_add_u32 s24, s35, 3
  s_and_b32 s24, s24, 3
  s_lshl_b32 s25, s34, 2
  s_add_u32 s25, s25, s35
  s_lshl_b32 s25, s25, 2
  s_add_u32 s25, s25, s24
  s_lshl_b32 s25, s25, 2
  s_add_u32 s25, s25, s33
  s_lshl_b32 s25, s25, 11
  s_add_u32 s25, s25, 0
  s_add_u32 s98, s90, s25
  s_addc_u32 s99, s91, 0
  global_load_dwordx4 v[248:251], v240, s[98:99] sc0 sc1
  s_cmp_lg_u32 s35, 0
  s_cbranch_scc1 L_noepo
  s_mov_b64 exec, 1
  v_mov_b32 v234, 0
  v_mov_b32 v235, s94
  global_store_dword v234, v235, s[92:93] sc0 sc1
  s_mov_b64 exec, -1
L_noepo:
  v_lshlrev_b32 v236, 16, v236
  v_lshlrev_b32 v237, 16, v237
  v_lshlrev_b32 v238, 16, v238
  v_lshlrev_b32 v239, 16, v239
  s_mov_b32 s36, 0xc0135761
  s_mov_b32 s37, 0xbdd2d3e8
  v_mov_b32 v40, s36
  s_waitcnt vmcnt(1)
  s_cmp_eq_u32 s35, 0
  s_cbranch_scc1 L_pl
  s_waitcnt vmcnt(0)
L_pl:
  v_lshlrev_b32 v0, 16, v224
  v_and_b32 v1, 0xffff0000, v224
  v_lshlrev_b32 v2, 16, v225
  v_and_b32 v3, 0xffff0000, v225
  v_lshlrev_b32 v4, 16, v226
  v_and_b32 v5, 0xffff0000, v226
  v_lshlrev_b32 v6, 16, v227
  v_and_b32 v7, 0xffff0000, v227
  v_lshlrev_b32 v8, 16, v244
  v_and_b32 v9, 0xffff0000, v244
  v_lshlrev_b32 v10, 16, v245
  v_and_b32 v11, 0xffff0000, v245
  v_lshlrev_b32 v12, 16, v246
  v_and_b32 v13, 0xffff0000, v246
  v_lshlrev_b32 v14, 16, v247
  v_and_b32 v15, 0xffff0000, v247
  v_lshlrev_b32 v16, 16, v248
  v_and_b32 v17, 0xffff0000, v248
  v_lshlrev_b32 v18, 16, v249
  v_and_b32 v19, 0xffff0000, v249
  v_lshlrev_b32 v20, 16, v250
  v_and_b32 v21, 0xffff0000, v250
  v_lshlrev_b32 v22, 16, v251
  v_and_b32 v23, 0xffff0000, v251
  v_add_f32 v0, v0, v8
  v_add_f32 v200, v200, v16
  v_add_f32 v1, v1, v9
  v_add_f32 v201, v201, v17
  v_add_f32 v2, v2, v10
  v_add_f32 v202, v202, v18
  v_add_f32 v3, v3, v11
  v_add_f32 v203, v203, v19
  v_add_f32 v4, v4, v12
  v_add_f32 v204, v204, v20
  v_add_f32 v5, v5, v13
  v_add_f32 v205, v205, v21
  v_add_f32 v6, v6, v14
  v_add_f32 v206, v206, v22
  v_add_f32 v7, v7, v15
  v_add_f32 v207, v207, v23
  v_add_f32 v0, v0, v200
  v_add_f32 v1, v1, v201
  v_add_f32 v2, v2, v202
  v_add_f32 v3, v3, v203
  v_add_f32 v4, v4, v204
  v_add_f32 v5, v5, v205
  v_add_f32 v6, v6, v206
  v_add_f32 v7, v7, v207
  v_add_f32 v0, v0, v236
  v_add_f32 v1, v1, v236
  v_add_f32 v2, v2, v236
  v_add_f32 v3, v3, v236
  v_add_f32 v4, v4, v237
  v_add_f32 v5, v5, v237
  v_add_f32 v6, v6, v237
  v_add_f32 v7, v7, v237
  v_mul_f32 v8, v0, v0
  v_mul_f32 v9, v1, v1
  v_mul_f32 v10, v2, v2
  v_mul_f32 v11, v3, v3
  v_mul_f32 v12, v4, v4
  v_mul_f32 v13, v5, v5
  v_mul_f32 v14, v6, v6
  v_mul_f32 v15, v7, v7
  v_fma_f32 v8, v8, s37, v40
  v_fma_f32 v9, v9, s37, v40
  v_fma_f32 v10, v10, s37, v40
  v_fma_f32 v11, v11, s37, v40
  v_fma_f32 v12, v12, s37, v40
  v_fma_f32 v13, v13, s37, v40
  v_fma_f32 v14, v14, s37, v40
  v_fma_f32 v15, v15, s37, v40
  v_mul_f32 v8, v8, v0
  v_mul_f32 v9, v9, v1
  v_mul_f32 v10, v10, v2
  v_mul_f32 v11, v11, v3
  v_mul_f32 v12, v12, v4
  v_mul_f32 v13, v13, v5
  v_mul_f32 v14, v14, v6
  v_mul_f32 v15, v15, v7
  v_exp_f32 v8, v8
  v_exp_f32 v9, v9
  v_exp_f32 v10, v10
  v_exp_f32 v11, v11
  v_exp_f32 v12, v12
  v_exp_f32 v13, v13
  v_exp_f32 v14, v14
  v_exp_f32 v15, v15
  v_add_f32 v8, 1.0, v8
  v_add_f32 v9, 1.0, v9
  v_add_f32 v10, 1.0, v10
  v_add_f32 v11, 1.0, v11
  v_add_f32 v12, 1.0, v12
  v_add_f32 v13, 1.0, v13
  v_add_f32 v14, 1.0, v14
  v_add_f32 v15, 1.0, v15
  v_rcp_f32 v8, v8
  v_rcp_f32 v9, v9
  v_rcp_f32 v10, v10
  v_rcp_f32 v11, v11
  v_rcp_f32 v12, v12
  v_rcp_f32 v13, v13
  v_rcp_f32 v14, v14
  v_rcp_f32 v15, v15
  v_mul_f32 v8, v8, v0
  v_mul_f32 v9, v9, v1
  v_mul_f32 v10, v10, v2
  v_mul_f32 v11, v11, v3
  v_mul_f32 v12, v12, v4
  v_mul_f32 v13, v13, v5
  v_mul_f32 v14, v14, v6
  v_mul_f32 v15, v15, v7
  v_mul_f32 v16, v8, v238
  v_mul_f32 v17, v9, v238
  v_mul_f32 v18, v10, v238
  v_mul_f32 v19, v11, v238
  v_fmac_f32 v16, v12, v239
  v_fmac_f32 v17, v13, v239
  v_fmac_f32 v18, v14, v239
  v_fmac_f32 v19, v15, v239
  v_add_f32_dpp v16, v16, v16 row_shr:1 row_mask:0xf bank_mask:0xf
  v_add_f32_dpp v17, v17, v17 row_shr:1 row_mask:0xf bank_mask:0xf
  v_add_f32_dpp v18, v18, v18 row_shr:1 row_mask:0xf bank_mask:0xf
  v_add_f32_dpp v19, v19, v19 row_shr:1 row_mask:0xf bank_mask:0xf
  v_add_f32_dpp v16, v16, v16 row_shr:2 row_mask:0xf bank_mask:0xf
  v_add_f32_dpp v17, v17, v17 row_shr:2 row_mask:0xf bank_mask:0xf
  v_add_f32_dpp v18, v18, v18 row_shr:2 row_mask:0xf bank_mask:0xf
  v_add_f32_dpp v19, v19, v19 row_shr:2 row_mask:0xf bank_mask:0xf
  v_add_f32_dpp v16, v16, v16 row_shr:4 row_mask:0xf bank_mask:0xf
  v_add_f32_dpp v17, v17, v17 row_shr:4 row_mask:0xf bank_mask:0xf
  v_add_f32_dpp v18, v18, v18 row_shr:4 row_mask:0xf bank_mask:0xf
  v_add_f32_dpp v19, v19, v19 row_shr:4 row_mask:0xf bank_mask:0xf
  v_add_f32_dpp v16, v16, v16 row_shr:8 row_mask:0xf bank_mask:0xf
  v_add_f32_dpp v17, v17, v17 row_shr:8 row_mask:0xf bank_mask:0xf
  v_add_f32_dpp v18, v18, v18 row_shr:8 row_mask:0xf bank_mask:0xf
  v_add_f32_dpp v19, v19, v19 row_shr:8 row_mask:0xf bank_mask:0xf
  v_lshrrev_b32 v21, 4, v253
  v_lshlrev_b32 v21, 4, v21
  s_lshl_b32 s24, s33, 6
  s_add_u32 s24, s24, 161888
  v_add_u32 v21, s24, v21
  s_mov_b32 exec_lo, 0x80008000
  s_mov_b32 exec_hi, 0x80008000
  ds_write_b128 v21, v[16:19]
  s_mov_b64 exec, -1
  s_waitcnt lgkmcnt(0)
  s_barrier
  s_endpgm
L_pnn:
  s_sub_u32 s95, s33, 4
  s_setprio 3
  s_mov_b32 s12, s76
  s_and_b32 s13, s77, 0xffff
  s_mov_b32 s14, 20000
  s_mov_b32 s15, 0x20000
  s_mov_b32 s28, s86
  s_and_b32 s29, s87, 0xffff
  s_mov_b32 s30, 8192
  s_mov_b32 s31, 0x20000
  s_load_dword s39, s[84:85], 0
  v_mov_b32 v190, v0
  s_mul_i32 s21, s95, 6
  s_cmp_ge_u32 s95, 1
  s_addc_u32 s21, s21, 0
  s_mul_i32 s26, s35, 25
  s_add_u32 s26, s26, s21
  s_lshl_b32 s89, s26, 2
  v_lshrrev_b32 v2, 2, v0
  v_and_b32 v3, 3, v0
  s_add_u32 s26, s35, 1
  s_and_b32 s26, s26, 3
  s_lshl_b32 s26, s26, 4
  s_lshl_b32 s38, s34, 6
  s_add_u32 s26, s26, s38
  v_add_u32 v4, s26, v2
  v_mul_u32_u24 v4, 400, v4
  v_lshl_add_u32 v4, v3, 3, v4
  buffer_load_dwordx2 v[236:237], v4, s[4:7], s89 offen
  s_add_u32 s26, s35, 2
  s_and_b32 s26, s26, 3
  s_lshl_b32 s26, s26, 4
  s_lshl_b32 s38, s34, 6
  s_add_u32 s26, s26, s38
  v_add_u32 v4, s26, v2
  v_mul_u32_u24 v4, 400, v4
  v_lshl_add_u32 v4, v3, 3, v4
  buffer_load_dwordx2 v[238:239], v4, s[4:7], s89 offen
  s_add_u32 s26, s35, 3
  s_and_b32 s26, s26, 3
  s_lshl_b32 s26, s26, 4
  s_lshl_b32 s38, s34, 6
  s_add_u32 s26, s26, s38
  v_add_u32 v4, s26, v2
  v_mul_u32_u24 v4, 400, v4
  v_lshl_add_u32 v4, v3, 3, v4
  buffer_load_dwordx2 v[240:241], v4, s[4:7], s89 offen
  v_lshrrev_b32 v5, 5, v0
  v_lshlrev_b32 v5, 1, v5
  v_xor_b32 v5, v5, v3
  v_lshlrev_b32 v242, 4, v5
  s_mul_i32 s89, s21, 1056
  s_lshl_b32 s24, s34, 6
  s_lshl_b32 s25, s35, 4
  s_add_u32 s24, s24, s25
  s_lshl_b32 s25, s95, 2
  s_add_u32 s24, s24, s25
  s_mul_i32 s24, s24, 400
  v_lshlrev_b32 v1, 4, v0
  s_mul_i32 s25, s95, 1600
  s_add_u32 s25, s25, 155424
  s_mov_b32 m0, s25
  s_nop 0
  buffer_load_dwordx4 v1, s[4:7], s24 offen lds
  s_mov_b32 exec_hi, 0xf
  buffer_load_dwordx4 v1, s[4:7], s24 offen offset:1024 lds
  s_mov_b64 exec, -1
  s_lshl_b32 s38, s95, 10
  s_add_u32 s26, s38, 132896
  s_mov_b32 m0, s26
  s_add_u32 s26, s26, 4096
  buffer_load_dwordx4 v1, s[12:15], s38 offen lds
  s_add_u32 s38, s38, 4096
  s_mov_b32 m0, s26
  s_add_u32 s26, s26, 4096
  buffer_load_dwordx4 v1, s[12:15], s38 offen lds
  s_add_u32 s38, s38, 4096
  s_mov_b32 m0, s26
  s_add_u32 s26, s26, 4096
  buffer_load_dwordx4 v1, s[12:15], s38 offen lds
  s_add_u32 s38, s38, 4096
  s_mov_b32 m0, s26
  s_add_u32 s26, s26, 4096
  buffer_load_dwordx4 v1, s[12:15], s38 offen lds
  s_add_u32 s38, s38, 4096
  s_mov_b32 m0, s26
  s_add_u32 s26, s26, 4096
  buffer_load_dwordx4 v1, s[12:15], s38 offen lds
  s_add_u32 s38, s38, 4096
  s_cmp_ge_u32 s95, 2
  s_cbranch_scc1 L_w5
  s_mov_b32 m0, s26
  s_add_u32 s26, s26, 4096
  buffer_load_dwordx4 v1, s[12:15], s38 offen lds
  s_add_u32 s38, s38, 4096
L_w5:
  v_and_b32 v7, 15, v0
  v_lshrrev_b32 v8, 4, v0
  v_lshlrev_b32 v9, 3, v8
  v_sub_u32 v9, v7, v9
  v_and_b32 v10, 1, v9
  v_lshlrev_b32 v10, 4, v10
  s_mov_b32 s26, 0x3f80
  v_lshlrev_b32 v10, v10, s26
  v_ashrrev_i32 v11, 1, v9
  v_add_u32 v12, 8, v11
  v_cmp_gt_u32 s[36:37], 4, v7
  v_cmp_eq_u32 vcc, 0, v11
  s_nop 1
  v_cndmask_b32 v178, 0, v10, vcc
  v_cmp_eq_u32 vcc, 0, v12
  s_nop 1
  v_cndmask_b32 v182, 0, v10, vcc
  v_cmp_eq_u32 vcc, 1, v11
  s_nop 1
  v_cndmask_b32 v179, 0, v10, vcc
  v_cmp_eq_u32 vcc, 1, v12
  s_nop 1
  v_cndmask_b32 v183, 0, v10, vcc
  v_cmp_eq_u32 vcc, 2, v11
  s_nop 1
  v_cndmask_b32 v180, 0, v10, vcc
  v_cmp_eq_u32 vcc, 2, v12
  s_nop 1
  v_cndmask_b32 v184, 0, v10, vcc
  v_cmp_eq_u32 vcc, 3, v11
  s_nop 1
  v_cndmask_b32 v181, 0, v10, vcc
  v_cmp_eq_u32 vcc, 3, v12
  s_nop 1
  v_cndmask_b32 v185, 0, v10, vcc
  v_cndmask_b32 v186, 0, v178, s[36:37]
  v_cndmask_b32 v187, 0, v179, s[36:37]
  v_cndmask_b32 v188, 0, v180, s[36:37]
  v_cndmask_b32 v189, 0, v181, s[36:37]
  v_mul_u32_u24 v13, 200, v7
  v_lshl_add_u32 v13, v8, 4, v13
  v_add_u32 v191, 132896, v13
  v_lshrrev_b32 v14, 2, v0
  v_and_b32 v14, 3, v14
  v_xor_b32 v14, v14, v8
  v_and_b32 v15, 3, v0
  v_lshlrev_b32 v177, 4, v15
  v_mul_u32_u24 v14, 400, v14
  v_lshl_add_u32 v14, v8, 2, v14
  v_add_u32 v14, s25, v14
  s_setprio 0
  s_waitcnt vmcnt(7)
  v_lshlrev_b32 v236, 6, v236
  v_lshlrev_b32 v237, 6, v237
  v_lshlrev_b32 v238, 6, v238
  v_lshlrev_b32 v239, 6, v239
  v_lshlrev_b32 v240, 6, v240
  v_lshlrev_b32 v241, 6, v241
  s_nop 1
  s_add_u32 m0, s89, 106496
  v_add_u32_dpp v118, v236, v242 quad_perm:[0,0,0,0] row_mask:0xf bank_mask:0xf
  buffer_load_dwordx4 v118, s[8:11], 0 offen lds
  s_add_u32 m0, m0, 1056
  v_add_u32_dpp v118, v237, v242 quad_perm:[0,0,0,0] row_mask:0xf bank_mask:0xf
  buffer_load_dwordx4 v118, s[8:11], 0 offen lds
  s_add_u32 m0, m0, 1056
  v_add_u32_dpp v118, v236, v242 quad_perm:[1,1,1,1] row_mask:0xf bank_mask:0xf
  buffer_load_dwordx4 v118, s[8:11], 0 offen lds
  s_add_u32 m0, m0, 1056
  v_add_u32_dpp v118, v237, v242 quad_perm:[1,1,1,1] row_mask:0xf bank_mask:0xf
  buffer_load_dwordx4 v118, s[8:11], 0 offen lds
  s_add_u32 m0, m0, 1056
  v_add_u32_dpp v118, v236, v242 quad_perm:[2,2,2,2] row_mask:0xf bank_mask:0xf
  buffer_load_dwordx4 v118, s[8:11], 0 offen lds
  s_add_u32 m0, m0, 1056
  v_add_u32_dpp v118, v237, v242 quad_perm:[2,2,2,2] row_mask:0xf bank_mask:0xf
  buffer_load_dwordx4 v118, s[8:11], 0 offen lds
  s_add_u32 m0, m0, 1056
  s_cmp_lg_u32 s95, 0
  s_cbranch_scc1 L_g6_0
  v_add_u32_dpp v118, v236, v242 quad_perm:[3,3,3,3] row_mask:0xf bank_mask:0xf
  buffer_load_dwordx4 v118, s[8:11], 0 offen lds
L_g6_0:
  s_waitcnt vmcnt(6)
  ds_read_b32 v152, v14 offset:0
  ds_read_b32 v153, v14 offset:16
  ds_read_b32 v154, v14 offset:32
  ds_read_b32 v155, v14 offset:48
  ds_read_b32 v156, v14 offset:64
  ds_read_b32 v157, v14 offset:80
  ds_read_b32 v158, v14 offset:96
  ds_read_b32 v159, v14 offset:112
  ds_read_b32 v160, v14 offset:128
  ds_read_b32 v161, v14 offset:144
  ds_read_b32 v162, v14 offset:160
  ds_read_b32 v163, v14 offset:176
  ds_read_b32 v164, v14 offset:192
  s_waitcnt lgkmcnt(0)
  ds_read_b32 v165, v14 offset:208
  ds_read_b32 v166, v14 offset:224
  ds_read_b32 v167, v14 offset:240
  ds_read_b32 v168, v14 offset:256
  ds_read_b32 v169, v14 offset:272
  ds_read_b32 v170, v14 offset:288
  ds_read_b32 v171, v14 offset:304
  ds_read_b32 v172, v14 offset:320
  ds_read_b32 v173, v14 offset:336
  ds_read_b32 v174, v14 offset:352
  ds_read_b32 v175, v14 offset:368
  ds_read_b32 v176, v14 offset:384
  s_mov_b64 exec, 1
  v_mov_b32 v16, 1
  ds_add_u32 v255, v16 offset:4
  s_mov_b64 exec, -1
  s_waitcnt lgkmcnt(0)
  v_lshl_add_u32 v152, v152, 6, v177
  v_lshl_add_u32 v153, v153, 6, v177
  v_lshl_add_u32 v154, v154, 6, v177
  v_lshl_add_u32 v155, v155, 6, v177
  v_lshl_add_u32 v156, v156, 6, v177
  v_lshl_add_u32 v157, v157, 6, v177
  v_lshl_add_u32 v158, v158, 6, v177
  v_lshl_add_u32 v159, v159, 6, v177
  v_lshl_add_u32 v160, v160, 6, v177
  v_lshl_add_u32 v161, v161, 6, v177
  v_lshl_add_u32 v162, v162, 6, v177
  v_lshl_add_u32 v163, v163, 6, v177
  v_lshl_add_u32 v164, v164, 6, v177
  v_lshl_add_u32 v165, v165, 6, v177
  v_lshl_add_u32 v166, v166, 6, v177
  v_lshl_add_u32 v167, v167, 6, v177
  v_lshl_add_u32 v168, v168, 6, v177
  v_lshl_add_u32 v169, v169, 6, v177
  v_lshl_add_u32 v170, v170, 6, v177
  v_lshl_add_u32 v171, v171, 6, v177
  v_lshl_add_u32 v172, v172, 6, v177
  v_lshl_add_u32 v173, v173, 6, v177
  v_lshl_add_u32 v174, v174, 6, v177
  v_lshl_add_u32 v175, v175, 6, v177
  v_lshl_add_u32 v176, v176, 6, v177
  s_mov_b32 s100, 0
L_poll_15:
  ds_read_b32 v16, v255 offset:4
  s_waitcnt lgkmcnt(0)
  v_readfirstlane_b32 s27, v16
  s_cmp_ge_u32 s27, 4
  s_cbranch_scc1 L_go_16
  s_add_u32 s100, s100, 1
  s_cmp_ge_u32 s100, 200000
  s_cbranch_scc1 L_go_16
  s_sleep 1
  s_branch L_poll_15
L_go_16:
  ds_read_b64 v[112:113], v191 offset:0
  ds_read_b64 v[114:115], v191 offset:8
  s_waitcnt lgkmcnt(0)
  v_mfma_f32_16x16x32_bf16 v[0:3], v[112:115], v[178:181], 0
  ds_read_b64 v[112:113], v191 offset:0
  ds_read_b64 v[114:115], v191 offset:8
  ds_read_b64 v[116:117], v191 offset:3200
  ds_read_b64 v[118:119], v191 offset:3208
  s_waitcnt lgkmcnt(0)
  v_mfma_f32_16x16x32_bf16 v[4:7], v[112:115], v[182:185], 0
  v_mfma_f32_16x16x32_bf16 v[4:7], v[178:181], v[116:119], v[4:7]
  v_mfma_f32_16x16x32_bf16 v[8:11], v[116:119], v[182:185], 0
  ds_read_b64 v[112:113], v191 offset:64
  ds_read_b64 v[114:115], v191 offset:72
  ds_read_b64 v[116:117], v191 offset:3264
  ds_read_b64 v[118:119], v191 offset:3272
  ds_read_b64 v[120:121], v191 offset:6464
  ds_read_b64 v[122:123], v191 offset:6472
  ds_read_b64 v[124:125], v191 offset:6400
  ds_read_b64 v[126:127], v191 offset:6408
  s_waitcnt lgkmcnt(0)
  v_mfma_f32_16x16x32_bf16 v[12:15], v[112:115], v[178:181], 0
  v_mfma_f32_16x16x32_bf16 v[12:15], v[178:181], v[124:127], v[12:15]
  v_mfma_f32_16x16x32_bf16 v[16:19], v[116:119], v[178:181], 0
  v_mfma_f32_16x16x32_bf16 v[16:19], v[182:185], v[124:127], v[16:19]
  v_mfma_f32_16x16x32_bf16 v[20:23], v[120:123], v[178:181], 0
  ds_read_b64 v[112:113], v191 offset:64
  ds_read_b64 v[114:115], v191 offset:72
  ds_read_b64 v[116:117], v191 offset:3264
  ds_read_b64 v[118:119], v191 offset:3272
  ds_read_b64 v[120:121], v191 offset:6464
  ds_read_b64 v[122:123], v191 offset:6472
  ds_read_b64 v[124:125], v191 offset:9664
  ds_read_b64 v[126:127], v191 offset:9672
  ds_read_b64 v[128:129], v191 offset:9600
  ds_read_b64 v[130:131], v191 offset:9608
  s_waitcnt lgkmcnt(0)
  v_mfma_f32_16x16x32_bf16 v[24:27], v[112:115], v[182:185], 0
  v_mfma_f32_16x16x32_bf16 v[24:27], v[178:181], v[128:131], v[24:27]
  v_mfma_f32_16x16x32_bf16 v[28:31], v[116:119], v[182:185], 0
  v_mfma_f32_16x16x32_bf16 v[28:31], v[182:185], v[128:131], v[28:31]
  v_mfma_f32_16x16x32_bf16 v[32:35], v[120:123], v[182:185], 0
  v_mfma_f32_16x16x32_bf16 v[32:35], v[178:181], v[124:127], v[32:35]
  v_mfma_f32_16x16x32_bf16 v[36:39], v[124:127], v[182:185], 0
  ds_read_b64 v[112:113], v191 offset:128
  ds_read_b64 v[114:115], v191 offset:136
  ds_read_b64 v[116:117], v191 offset:3328
  ds_read_b64 v[118:119], v191 offset:3336
  ds_read_b64 v[120:121], v191 offset:6528
  ds_read_b64 v[122:123], v191 offset:6536
  ds_read_b64 v[124:125], v191 offset:9728
  ds_read_b64 v[126:127], v191 offset:9736
  ds_read_b64 v[128:129], v191 offset:12928
  ds_read_b64 v[130:131], v191 offset:12936
  ds_read_b64 v[132:133], v191 offset:12800
  ds_read_b64 v[134:135], v191 offset:12808
  ds_read_b64 v[136:137], v191 offset:12864
  ds_read_b64 v[138:139], v191 offset:12872
  s_waitcnt lgkmcnt(6)
  s_waitcnt lgkmcnt(0)
  v_mfma_f32_16x16x32_bf16 v[40:43], v[112:115], v[178:181], 0
  v_mfma_f32_16x16x32_bf16 v[40:43], v[178:181], v[132:135], v[40:43]
  v_mfma_f32_16x16x32_bf16 v[44:47], v[116:119], v[178:181], 0
  v_mfma_f32_16x16x32_bf16 v[44:47], v[182:185], v[132:135], v[44:47]
  v_mfma_f32_16x16x32_bf16 v[48:51], v[120:123], v[178:181], 0
  v_mfma_f32_16x16x32_bf16 v[48:51], v[178:181], v[136:139], v[48:51]
  v_mfma_f32_16x16x32_bf16 v[52:55], v[124:127], v[178:181], 0
  v_mfma_f32_16x16x32_bf16 v[52:55], v[182:185], v[136:139], v[52:55]
  v_mfma_f32_16x16x32_bf16 v[56:59], v[128:131], v[178:181], 0
  ds_read_b64 v[112:113], v191 offset:128
  ds_read_b64 v[114:115], v191 offset:136
  ds_read_b64 v[116:117], v191 offset:3328
  ds_read_b64 v[118:119], v191 offset:3336
  ds_read_b64 v[120:121], v191 offset:6528
  ds_read_b64 v[122:123], v191 offset:6536
  ds_read_b64 v[124:125], v191 offset:9728
  ds_read_b64 v[126:127], v191 offset:9736
  ds_read_b64 v[128:129], v191 offset:12928
  ds_read_b64 v[130:131], v191 offset:12936
  ds_read_b64 v[132:133], v191 offset:16128
  ds_read_b64 v[134:135], v191 offset:16136
  ds_read_b64 v[136:137], v191 offset:16000
  ds_read_b64 v[138:139], v191 offset:16008
  s_waitcnt lgkmcnt(6)
  ds_read_b64 v[140:141], v191 offset:16064
  ds_read_b64 v[142:143], v191 offset:16072
  s_waitcnt lgkmcnt(0)
  v_mfma_f32_16x16x32_bf16 v[60:63], v[112:115], v[182:185], 0
  v_mfma_f32_16x16x32_bf16 v[60:63], v[178:181], v[136:139], v[60:63]
  v_mfma_f32_16x16x32_bf16 v[64:67], v[116:119], v[182:185], 0
  v_mfma_f32_16x16x32_bf16 v[64:67], v[182:185], v[136:139], v[64:67]
  v_mfma_f32_16x16x32_bf16 v[68:71], v[120:123], v[182:185], 0
  v_mfma_f32_16x16x32_bf16 v[68:71], v[178:181], v[140:143], v[68:71]
  v_mfma_f32_16x16x32_bf16 v[72:75], v[124:127], v[182:185], 0
  v_mfma_f32_16x16x32_bf16 v[72:75], v[182:185], v[140:143], v[72:75]
  v_mfma_f32_16x16x32_bf16 v[76:79], v[128:131], v[182:185], 0
  v_mfma_f32_16x16x32_bf16 v[76:79], v[178:181], v[132:135], v[76:79]
  v_mfma_f32_16x16x32_bf16 v[80:83], v[132:135], v[182:185], 0
  ds_read_b64 v[112:113], v191 offset:192
  ds_read_b64 v[114:115], v191 offset:200
  ds_read_b64 v[116:117], v191 offset:3392
  ds_read_b64 v[118:119], v191 offset:3400
  ds_read_b64 v[120:121], v191 offset:6592
  ds_read_b64 v[122:123], v191 offset:6600
  ds_read_b64 v[124:125], v191 offset:9792
  ds_read_b64 v[126:127], v191 offset:9800
  ds_read_b64 v[128:129], v191 offset:12992
  ds_read_b64 v[130:131], v191 offset:13000
  ds_read_b64 v[132:133], v191 offset:16192
  ds_read_b64 v[134:135], v191 offset:16200
  ds_read_b64 v[136:137], v191 offset:19392
  ds_read_b64 v[138:139], v191 offset:19400
  s_waitcnt lgkmcnt(6)
  ds_read_b64 v[140:141], v191 offset:19200
  ds_read_b64 v[142:143], v191 offset:19208
  ds_read_b64 v[144:145], v191 offset:19264
  ds_read_b64 v[146:147], v191 offset:19272
  ds_read_b64 v[148:149], v191 offset:19328
  ds_read_b64 v[150:151], v191 offset:19336
  s_waitcnt lgkmcnt(0)
  v_mfma_f32_16x16x32_bf16 v[84:87], v[112:115], v[186:189], 0
  v_mfma_f32_16x16x32_bf16 v[84:87], v[178:181], v[140:143], v[84:87]
  v_mfma_f32_16x16x32_bf16 v[88:91], v[116:119], v[186:189], 0
  v_mfma_f32_16x16x32_bf16 v[88:91], v[182:185], v[140:143], v[88:91]
  v_mfma_f32_16x16x32_bf16 v[92:95], v[120:123], v[186:189], 0
  v_mfma_f32_16x16x32_bf16 v[92:95], v[178:181], v[144:147], v[92:95]
  v_mfma_f32_16x16x32_bf16 v[96:99], v[124:127], v[186:189], 0
  v_mfma_f32_16x16x32_bf16 v[96:99], v[182:185], v[144:147], v[96:99]
  v_mfma_f32_16x16x32_bf16 v[100:103], v[128:131], v[186:189], 0
  v_mfma_f32_16x16x32_bf16 v[100:103], v[178:181], v[148:151], v[100:103]
  v_mfma_f32_16x16x32_bf16 v[104:107], v[132:135], v[186:189], 0
  v_mfma_f32_16x16x32_bf16 v[104:107], v[182:185], v[148:151], v[104:107]
  v_mfma_f32_16x16x32_bf16 v[108:111], v[136:139], v[186:189], 0
  s_mov_b64 exec, 1
  v_mov_b32 v112, 1
  ds_add_u32 v255, v112 offset:8
  s_mov_b64 exec, -1
  s_setprio 0
  s_mul_i32 s24, s95, 26400
  s_add_u32 s24, s24, 0
  v_and_b32 v112, 15, v190
  v_lshrrev_b32 v113, 4, v190
  v_lshrrev_b32 v114, 2, v112
  v_and_b32 v115, 3, v112
  v_lshlrev_b32 v116, 8, v115
  v_lshl_add_u32 v116, v113, 4, v116
  v_add_u32 v116, s24, v116
  v_mul_u32_u24 v117, 1056, v114
  v_xor_b32 v118, 0, v115
  v_lshl_add_u32 v216, v118, 6, v116
  v_add_u32 v212, v216, v117
  v_xor_b32 v118, 1, v115
  v_lshl_add_u32 v217, v118, 6, v116
  v_add_u32 v213, v217, v117
  v_xor_b32 v118, 2, v115
  v_lshl_add_u32 v218, v118, 6, v116
  v_add_u32 v214, v218, v117
  v_xor_b32 v118, 3, v115
  v_lshl_add_u32 v219, v118, 6, v116
  v_add_u32 v215, v219, v117
  v_mov_b32 v192, 0
  v_mov_b32 v193, 0
  v_mov_b32 v194, 0
  v_mov_b32 v195, 0
  v_mov_b32 v196, 0
  v_mov_b32 v197, 0
  v_mov_b32 v198, 0
  v_mov_b32 v199, 0
  v_mov_b32 v200, 0
  v_mov_b32 v201, 0
  v_mov_b32 v202, 0
  v_mov_b32 v203, 0
  v_mov_b32 v204, 0
  v_mov_b32 v205, 0
  v_mov_b32 v206, 0
  v_mov_b32 v207, 0
  s_waitcnt vmcnt(0)
  s_mov_b64 exec, 1
  v_mov_b32 v118, 1
  ds_add_u32 v255, v118 offset:12
  s_mov_b64 exec, -1
  s_mov_b32 s100, 0
L_poll_17:
  ds_read_b32 v118, v255 offset:8
  s_waitcnt lgkmcnt(0)
  v_readfirstlane_b32 s27, v118
  s_cmp_ge_u32 s27, 4
  s_cbranch_scc1 L_go_18
  s_add_u32 s100, s100, 1
  s_cmp_ge_u32 s100, 200000
  s_cbranch_scc1 L_go_18
  s_sleep 1
  s_branch L_poll_17
L_go_18:
  s_add_u32 m0, s89, 132896
  v_add_u32_dpp v118, v238, v242 quad_perm:[0,0,0,0] row_mask:0xf bank_mask:0xf
  buffer_load_dwordx4 v118, s[8:11], 0 offen lds
  s_add_u32 m0, m0, 1056
  v_add_u32_dpp v118, v239, v242 quad_perm:[0,0,0,0] row_mask:0xf bank_mask:0xf
  buffer_load_dwordx4 v118, s[8:11], 0 offen lds
  s_add_u32 m0, m0, 1056
  v_add_u32_dpp v118, v238, v242 quad_perm:[1,1,1,1] row_mask:0xf bank_mask:0xf
  buffer_load_dwordx4 v118, s[8:11], 0 offen lds
  s_add_u32 m0, m0, 1056
  v_add_u32_dpp v118, v239, v242 quad_perm:[1,1,1,1] row_mask:0xf bank_mask:0xf
  buffer_load_dwordx4 v118, s[8:11], 0 offen lds
  s_add_u32 m0, m0, 1056
  v_add_u32_dpp v118, v238, v242 quad_perm:[2,2,2,2] row_mask:0xf bank_mask:0xf
  buffer_load_dwordx4 v118, s[8:11], 0 offen lds
  s_add_u32 m0, m0, 1056
  v_add_u32_dpp v118, v239, v242 quad_perm:[2,2,2,2] row_mask:0xf bank_mask:0xf
  buffer_load_dwordx4 v118, s[8:11], 0 offen lds
  s_add_u32 m0, m0, 1056
  s_cmp_lg_u32 s95, 0
  s_cbranch_scc1 L_g6_1
  v_add_u32_dpp v118, v238, v242 quad_perm:[3,3,3,3] row_mask:0xf bank_mask:0xf
  buffer_load_dwordx4 v118, s[8:11], 0 offen lds
L_g6_1:
  s_mov_b32 s100, 0
L_poll_19:
  ds_read_b32 v118, v255 offset:0
  s_waitcnt lgkmcnt(0)
  v_readfirstlane_b32 s27, v118
  s_cmp_ge_u32 s27, 16
  s_cbranch_scc1 L_go_20
  s_add_u32 s100, s100, 1
  s_cmp_ge_u32 s100, 200000
  s_cbranch_scc1 L_go_20
  s_sleep 1
  s_branch L_poll_19
L_go_20:
  s_add_u32 m0, s24, 0
  s_nop 0
  buffer_load_dwordx4 v152, s[8:11], 0 offen lds
  s_add_u32 m0, s24, 1056
  s_nop 0
  buffer_load_dwordx4 v153, s[8:11], 0 offen lds
  s_waitcnt vmcnt(2)
  s_mov_b64 exec, 1
  v_mov_b32 v118, 1
  ds_add_u32 v255, v118 offset:32
  s_mov_b64 exec, -1
  s_add_u32 m0, s24, 2112
  s_nop 0
  buffer_load_dwordx4 v154, s[8:11], 0 offen lds
  s_add_u32 m0, s24, 3168
  s_nop 0
  buffer_load_dwordx4 v155, s[8:11], 0 offen lds
  s_add_u32 m0, s24, 4224
  s_nop 0
  buffer_load_dwordx4 v156, s[8:11], 0 offen lds
  s_add_u32 m0, s24, 5280
  s_nop 0
  buffer_load_dwordx4 v157, s[8:11], 0 offen lds
  s_add_u32 m0, s24, 6336
  s_nop 0
  buffer_load_dwordx4 v158, s[8:11], 0 offen lds
  s_add_u32 m0, s24, 7392
  s_nop 0
  buffer_load_dwordx4 v159, s[8:11], 0 offen lds
  s_mov_b32 s100, 0
L_poll_21:
  ds_read_b32 v118, v255 offset:16
  s_waitcnt lgkmcnt(0)
  v_readfirstlane_b32 s27, v118
  s_cmp_ge_u32 s27, 4
  s_cbranch_scc1 L_go_22
  s_add_u32 s100, s100, 1
  s_cmp_ge_u32 s100, 200000
  s_cbranch_scc1 L_go_22
  s_sleep 1
  s_branch L_poll_21
L_go_22:
  s_add_u32 m0, s89, 106496
  v_add_u32_dpp v118, v240, v242 quad_perm:[0,0,0,0] row_mask:0xf bank_mask:0xf
  buffer_load_dwordx4 v118, s[8:11], 0 offen lds
  s_add_u32 m0, m0, 1056
  v_add_u32_dpp v118, v241, v242 quad_perm:[0,0,0,0] row_mask:0xf bank_mask:0xf
  buffer_load_dwordx4 v118, s[8:11], 0 offen lds
  s_add_u32 m0, m0, 1056
  v_add_u32_dpp v118, v240, v242 quad_perm:[1,1,1,1] row_mask:0xf bank_mask:0xf
  buffer_load_dwordx4 v118, s[8:11], 0 offen lds
  s_add_u32 m0, m0, 1056
  v_add_u32_dpp v118, v241, v242 quad_perm:[1,1,1,1] row_mask:0xf bank_mask:0xf
  buffer_load_dwordx4 v118, s[8:11], 0 offen lds
  s_add_u32 m0, m0, 1056
  v_add_u32_dpp v118, v240, v242 quad_perm:[2,2,2,2] row_mask:0xf bank_mask:0xf
  buffer_load_dwordx4 v118, s[8:11], 0 offen lds
  s_add_u32 m0, m0, 1056
  v_add_u32_dpp v118, v241, v242 quad_perm:[2,2,2,2] row_mask:0xf bank_mask:0xf
  buffer_load_dwordx4 v118, s[8:11], 0 offen lds
  s_add_u32 m0, m0, 1056
  s_cmp_lg_u32 s95, 0
  s_cbranch_scc1 L_g6_2
  v_add_u32_dpp v118, v240, v242 quad_perm:[3,3,3,3] row_mask:0xf bank_mask:0xf
  buffer_load_dwordx4 v118, s[8:11], 0 offen lds
L_g6_2:
  s_add_u32 m0, s24, 8448
  s_nop 0
  buffer_load_dwordx4 v160, s[8:11], 0 offen lds
  s_add_u32 m0, s24, 9504
  s_nop 0
  buffer_load_dwordx4 v161, s[8:11], 0 offen lds
  s_add_u32 m0, s24, 10560
  s_nop 0
  buffer_load_dwordx4 v162, s[8:11], 0 offen lds
  s_waitcnt vmcnt(3)
  s_mov_b64 exec, 1
  v_mov_b32 v118, 1
  ds_add_u32 v255, v118 offset:36
  s_mov_b64 exec, -1
  s_add_u32 m0, s24, 11616
  s_nop 0
  buffer_load_dwordx4 v163, s[8:11], 0 offen lds
  s_waitcnt vmcnt(8)
  ds_read_b128 v[112:115], v212 offset:0
  s_add_u32 m0, s24, 12672
  s_nop 0
  buffer_load_dwordx4 v164, s[8:11], 0 offen lds
  s_waitcnt vmcnt(9)
  ds_read_b128 v[220:223], v213 offset:0
  s_waitcnt lgkmcnt(1)
  v_mfma_f32_16x16x32_bf16 v[140:143], v[112:115], v[112:115], 0
  s_add_u32 m0, s24, 13728
  s_nop 0
  buffer_load_dwordx4 v165, s[8:11], 0 offen lds
  s_waitcnt vmcnt(10)
  ds_read_b128 v[112:115], v214 offset:0
  s_waitcnt lgkmcnt(1)
  v_mfma_f32_16x16x32_bf16 v[144:147], v[220:223], v[220:223], 0
  s_add_u32 m0, s24, 14784
  s_nop 0
  buffer_load_dwordx4 v166, s[8:11], 0 offen lds
  s_waitcnt vmcnt(11)
  ds_read_b128 v[220:223], v215 offset:0
  s_waitcnt lgkmcnt(1)
  v_mfma_f32_16x16x32_bf16 v[148:151], v[112:115], v[112:115], 0
  s_nop 5
  v_fmac_f32 v192, v140, v0
  v_fmac_f32 v193, v141, v1
  v_fmac_f32 v194, v142, v2
  v_fmac_f32 v195, v143, v3
  s_add_u32 m0, s24, 15840
  s_nop 0
  buffer_load_dwordx4 v167, s[8:11], 0 offen lds
  s_waitcnt vmcnt(8)
  ds_read_b128 v[112:115], v212 offset:0
  ds_read_b128 v[116:119], v212 offset:4224
  s_waitcnt lgkmcnt(2)
  v_mfma_f32_16x16x32_bf16 v[140:143], v[220:223], v[220:223], 0
  v_fmac_f32 v196, v144, v0
  v_fmac_f32 v197, v145, v1
  v_fmac_f32 v198, v146, v2
  v_fmac_f32 v199, v147, v3
  s_add_u32 m0, s24, 16896
  s_nop 0
  buffer_load_dwordx4 v168, s[8:11], 0 offen lds
  s_waitcnt vmcnt(9)
  ds_read_b128 v[220:223], v213 offset:0
  ds_read_b128 v[224:227], v213 offset:4224
  s_waitcnt lgkmcnt(2)
  v_mfma_f32_16x16x32_bf16 v[144:147], v[112:115], v[116:119], 0
  v_fmac_f32 v200, v148, v0
  v_fmac_f32 v201, v149, v1
  v_fmac_f32 v202, v150, v2
  v_fmac_f32 v203, v151, v3
  v_mfma_f32_16x16x32_bf16 v[148:151], v[116:119], v[116:119], 0
  v_fmac_f32 v204, v140, v0
  v_fmac_f32 v205, v141, v1
  v_fmac_f32 v206, v142, v2
  v_fmac_f32 v207, v143, v3
  s_add_u32 m0, s24, 17952
  s_nop 0
  buffer_load_dwordx4 v169, s[8:11], 0 offen lds
  s_waitcnt vmcnt(10)
  ds_read_b128 v[112:115], v214 offset:0
  ds_read_b128 v[116:119], v214 offset:4224
  s_waitcnt lgkmcnt(2)
  v_mfma_f32_16x16x32_bf16 v[140:143], v[220:223], v[224:227], 0
  v_fmac_f32 v192, v144, v4
  v_fmac_f32 v193, v145, v5
  v_fmac_f32 v194, v146, v6
  v_fmac_f32 v195, v147, v7
  v_mfma_f32_16x16x32_bf16 v[144:147], v[224:227], v[224:227], 0
  v_fmac_f32 v192, v148, v8
  v_fmac_f32 v193, v149, v9
  v_fmac_f32 v194, v150, v10
  v_fmac_f32 v195, v151, v11
  s_add_u32 m0, s24, 19008
  s_nop 0
  buffer_load_dwordx4 v170, s[8:11], 0 offen lds
  s_waitcnt vmcnt(11)
  ds_read_b128 v[220:223], v215 offset:0
  ds_read_b128 v[224:227], v215 offset:4224
  s_waitcnt lgkmcnt(2)
  v_mfma_f32_16x16x32_bf16 v[148:151], v[112:115], v[116:119], 0
  v_fmac_f32 v196, v140, v4
  v_fmac_f32 v197, v141, v5
  v_fmac_f32 v198, v142, v6
  v_fmac_f32 v199, v143, v7
  v_mfma_f32_16x16x32_bf16 v[140:143], v[116:119], v[116:119], 0
  v_fmac_f32 v196, v144, v8
  v_fmac_f32 v197, v145, v9
  v_fmac_f32 v198, v146, v10
  v_fmac_f32 v199, v147, v11
  s_add_u32 m0, s24, 20064
  s_nop 0
  buffer_load_dwordx4 v171, s[8:11], 0 offen lds
  s_waitcnt vmcnt(8)
  ds_read_b128 v[112:115], v212 offset:0
  ds_read_b128 v[116:119], v212 offset:4224
  ds_read_b128 v[120:123], v212 offset:8448
  s_waitcnt lgkmcnt(3)
  v_mfma_f32_16x16x32_bf16 v[144:147], v[220:223], v[224:227], 0
  v_fmac_f32 v200, v148, v4
  v_fmac_f32 v201, v149, v5
  v_fmac_f32 v202, v150, v6
  v_fmac_f32 v203, v151, v7
  v_mfma_f32_16x16x32_bf16 v[148:151], v[224:227], v[224:227], 0
  v_fmac_f32 v200, v140, v8
  v_fmac_f32 v201, v141, v9
  v_fmac_f32 v202, v142, v10
  v_fmac_f32 v203, v143, v11
  s_add_u32 m0, s24, 21120
  s_nop 0
  buffer_load_dwordx4 v172, s[8:11], 0 offen lds
  s_waitcnt vmcnt(9)
  ds_read_b128 v[220:223], v213 offset:0
  ds_read_b128 v[224:227], v213 offset:4224
  ds_read_b128 v[228:231], v213 offset:8448
  s_waitcnt lgkmcnt(3)
  v_mfma_f32_16x16x32_bf16 v[140:143], v[112:115], v[120:123], 0
  v_fmac_f32 v204, v144, v4
  v_fmac_f32 v205, v145, v5
  v_fmac_f32 v206, v146, v6
  v_fmac_f32 v207, v147, v7
  v_mfma_f32_16x16x32_bf16 v[144:147], v[116:119], v[120:123], 0
  v_fmac_f32 v204, v148, v8
  v_fmac_f32 v205, v149, v9
  v_fmac_f32 v206, v150, v10
  v_fmac_f32 v207, v151, v11
  v_mfma_f32_16x16x32_bf16 v[148:151], v[120:123], v[120:123], 0
  v_fmac_f32 v192, v140, v12
  v_fmac_f32 v193, v141, v13
  v_fmac_f32 v194, v142, v14
  v_fmac_f32 v195, v143, v15
  s_add_u32 m0, s24, 22176
  s_nop 0
  buffer_load_dwordx4 v173, s[8:11], 0 offen lds
  s_waitcnt vmcnt(10)
  ds_read_b128 v[112:115], v214 offset:0
  ds_read_b128 v[116:119], v214 offset:4224
  ds_read_b128 v[120:123], v214 offset:8448
  s_waitcnt lgkmcnt(3)
  v_mfma_f32_16x16x32_bf16 v[140:143], v[220:223], v[228:231], 0
  v_fmac_f32 v192, v144, v16
  v_fmac_f32 v193, v145, v17
  v_fmac_f32 v194, v146, v18
  v_fmac_f32 v195, v147, v19
  v_mfma_f32_16x16x32_bf16 v[144:147], v[224:227], v[228:231], 0
  v_fmac_f32 v192, v148, v20
  v_fmac_f32 v193, v149, v21
  v_fmac_f32 v194, v150, v22
  v_fmac_f32 v195, v151, v23
  v_mfma_f32_16x16x32_bf16 v[148:151], v[228:231], v[228:231], 0
  v_fmac_f32 v196, v140, v12
  v_fmac_f32 v197, v141, v13
  v_fmac_f32 v198, v142, v14
  v_fmac_f32 v199, v143, v15
  s_add_u32 m0, s24, 23232
  s_nop 0
  buffer_load_dwordx4 v174, s[8:11], 0 offen lds
  s_waitcnt vmcnt(11)
  ds_read_b128 v[220:223], v215 offset:0
  ds_read_b128 v[224:227], v215 offset:4224
  ds_read_b128 v[228:231], v215 offset:8448
  s_waitcnt lgkmcnt(3)
  v_mfma_f32_16x16x32_bf16 v[140:143], v[112:115], v[120:123], 0
  v_fmac_f32 v196, v144, v16
  v_fmac_f32 v197, v145, v17
  v_fmac_f32 v198, v146, v18
  v_fmac_f32 v199, v147, v19
  v_mfma_f32_16x16x32_bf16 v[144:147], v[116:119], v[120:123], 0
  v_fmac_f32 v196, v148, v20
  v_fmac_f32 v197, v149, v21
  v_fmac_f32 v198, v150, v22
  v_fmac_f32 v199, v151, v23
  v_mfma_f32_16x16x32_bf16 v[148:151], v[120:123], v[120:123], 0
  v_fmac_f32 v200, v140, v12
  v_fmac_f32 v201, v141, v13
  v_fmac_f32 v202, v142, v14
  v_fmac_f32 v203, v143, v15
  s_add_u32 m0, s24, 24288
  s_nop 0
  buffer_load_dwordx4 v175, s[8:11], 0 offen lds
  s_waitcnt vmcnt(8)
  ds_read_b128 v[112:115], v212 offset:0
  ds_read_b128 v[116:119], v212 offset:4224
  ds_read_b128 v[120:123], v212 offset:8448
  ds_read_b128 v[124:127], v212 offset:12672
  s_waitcnt lgkmcnt(4)
  v_mfma_f32_16x16x32_bf16 v[140:143], v[220:223], v[228:231], 0
  v_fmac_f32 v200, v144, v16
  v_fmac_f32 v201, v145, v17
  v_fmac_f32 v202, v146, v18
  v_fmac_f32 v203, v147, v19
  v_mfma_f32_16x16x32_bf16 v[144:147], v[224:227], v[228:231], 0
  v_fmac_f32 v200, v148, v20
  v_fmac_f32 v201, v149, v21
  v_fmac_f32 v202, v150, v22
  v_fmac_f32 v203, v151, v23
  v_mfma_f32_16x16x32_bf16 v[148:151], v[228:231], v[228:231], 0
  v_fmac_f32 v204, v140, v12
  v_fmac_f32 v205, v141, v13
  v_fmac_f32 v206, v142, v14
  v_fmac_f32 v207, v143, v15
  s_add_u32 m0, s24, 25344
  s_nop 0
  buffer_load_dwordx4 v176, s[8:11], 0 offen lds
  s_mov_b64 exec, 1
  v_mov_b32 v250, 1
  ds_add_u32 v255, v250 offset:28
  s_mov_b64 exec, -1
  s_waitcnt vmcnt(9)
  ds_read_b128 v[220:223], v213 offset:0
  ds_read_b128 v[224:227], v213 offset:4224
  ds_read_b128 v[228:231], v213 offset:8448
  ds_read_b128 v[232:235], v213 offset:12672
  s_waitcnt lgkmcnt(4)
  v_mfma_f32_16x16x32_bf16 v[140:143], v[112:115], v[124:127], 0
  v_fmac_f32 v204, v144, v16
  v_fmac_f32 v205, v145, v17
  v_fmac_f32 v206, v146, v18
  v_fmac_f32 v207, v147, v19
  v_mfma_f32_16x16x32_bf16 v[144:147], v[116:119], v[124:127], 0
  v_fmac_f32 v204, v148, v20
  v_fmac_f32 v205, v149, v21
  v_fmac_f32 v206, v150, v22
  v_fmac_f32 v207, v151, v23
  v_mfma_f32_16x16x32_bf16 v[148:151], v[120:123], v[124:127], 0
  v_fmac_f32 v192, v140, v24
  v_fmac_f32 v193, v141, v25
  v_fmac_f32 v194, v142, v26
  v_fmac_f32 v195, v143, v27
  v_mfma_f32_16x16x32_bf16 v[140:143], v[124:127], v[124:127], 0
  v_fmac_f32 v192, v144, v28
  v_fmac_f32 v193, v145, v29
  v_fmac_f32 v194, v146, v30
  v_fmac_f32 v195, v147, v31
  ds_read_b128 v[112:115], v214 offset:0
  ds_read_b128 v[116:119], v214 offset:4224
  ds_read_b128 v[120:123], v214 offset:8448
  ds_read_b128 v[124:127], v214 offset:12672
  s_waitcnt lgkmcnt(4)
  v_mfma_f32_16x16x32_bf16 v[144:147], v[220:223], v[232:235], 0
  v_fmac_f32 v192, v148, v32
  v_fmac_f32 v193, v149, v33
  v_fmac_f32 v194, v150, v34
  v_fmac_f32 v195, v151, v35
  v_mfma_f32_16x16x32_bf16 v[148:151], v[224:227], v[232:235], 0
  v_fmac_f32 v192, v140, v36
  v_fmac_f32 v193, v141, v37
  v_fmac_f32 v194, v142, v38
  v_fmac_f32 v195, v143, v39
  v_mfma_f32_16x16x32_bf16 v[140:143], v[228:231], v[232:235], 0
  v_fmac_f32 v196, v144, v24
  v_fmac_f32 v197, v145, v25
  v_fmac_f32 v198, v146, v26
  v_fmac_f32 v199, v147, v27
  v_mfma_f32_16x16x32_bf16 v[144:147], v[232:235], v[232:235], 0
  v_fmac_f32 v196, v148, v28
  v_fmac_f32 v197, v149, v29
  v_fmac_f32 v198, v150, v30
  v_fmac_f32 v199, v151, v31
  ds_read_b128 v[220:223], v215 offset:0
  ds_read_b128 v[224:227], v215 offset:4224
  ds_read_b128 v[228:231], v215 offset:8448
  ds_read_b128 v[232:235], v215 offset:12672
  s_waitcnt lgkmcnt(4)
  v_mfma_f32_16x16x32_bf16 v[148:151], v[112:115], v[124:127], 0
  v_fmac_f32 v196, v140, v32
  v_fmac_f32 v197, v141, v33
  v_fmac_f32 v198, v142, v34
  v_fmac_f32 v199, v143, v35
  v_mfma_f32_16x16x32_bf16 v[140:143], v[116:119], v[124:127], 0
  v_fmac_f32 v196, v144, v36
  v_fmac_f32 v197, v145, v37
  v_fmac_f32 v198, v146, v38
  v_fmac_f32 v199, v147, v39
  v_mfma_f32_16x16x32_bf16 v[144:147], v[120:123], v[124:127], 0
  v_fmac_f32 v200, v148, v24
  v_fmac_f32 v201, v149, v25
  v_fmac_f32 v202, v150, v26
  v_fmac_f32 v203, v151, v27
  v_mfma_f32_16x16x32_bf16 v[148:151], v[124:127], v[124:127], 0
  v_fmac_f32 v200, v140, v28
  v_fmac_f32 v201, v141, v29
  v_fmac_f32 v202, v142, v30
  v_fmac_f32 v203, v143, v31
  s_waitcnt vmcnt(5)
  ds_read_b128 v[112:115], v212 offset:0
  ds_read_b128 v[116:119], v212 offset:4224
  ds_read_b128 v[120:123], v212 offset:8448
  ds_read_b128 v[124:127], v212 offset:12672
  ds_read_b128 v[128:131], v212 offset:16896
  s_waitcnt lgkmcnt(5)
  v_mfma_f32_16x16x32_bf16 v[140:143], v[220:223], v[232:235], 0
  v_fmac_f32 v200, v144, v32
  v_fmac_f32 v201, v145, v33
  v_fmac_f32 v202, v146, v34
  v_fmac_f32 v203, v147, v35
  v_mfma_f32_16x16x32_bf16 v[144:147], v[224:227], v[232:235], 0
  v_fmac_f32 v200, v148, v36
  v_fmac_f32 v201, v149, v37
  v_fmac_f32 v202, v150, v38
  v_fmac_f32 v203, v151, v39
  v_mfma_f32_16x16x32_bf16 v[148:151], v[228:231], v[232:235], 0
  v_fmac_f32 v204, v140, v24
  v_fmac_f32 v205, v141, v25
  v_fmac_f32 v206, v142, v26
  v_fmac_f32 v207, v143, v27
  v_mfma_f32_16x16x32_bf16 v[140:143], v[232:235], v[232:235], 0
  v_fmac_f32 v204, v144, v28
  v_fmac_f32 v205, v145, v29
  v_fmac_f32 v206, v146, v30
  v_fmac_f32 v207, v147, v31
  ds_read_b128 v[220:223], v213 offset:0
  ds_read_b128 v[224:227], v213 offset:4224
  ds_read_b128 v[228:231], v213 offset:8448
  ds_read_b128 v[232:235], v213 offset:12672
  ds_read_b128 v[236:239], v213 offset:16896
  s_waitcnt lgkmcnt(5)
  v_mfma_f32_16x16x32_bf16 v[144:147], v[112:115], v[128:131], 0
  v_fmac_f32 v204, v148, v32
  v_fmac_f32 v205, v149, v33
  v_fmac_f32 v206, v150, v34
  v_fmac_f32 v207, v151, v35
  v_mfma_f32_16x16x32_bf16 v[148:151], v[116:119], v[128:131], 0
  v_fmac_f32 v204, v140, v36
  v_fmac_f32 v205, v141, v37
  v_fmac_f32 v206, v142, v38
  v_fmac_f32 v207, v143, v39
  v_mfma_f32_16x16x32_bf16 v[140:143], v[120:123], v[128:131], 0
  v_fmac_f32 v192, v144, v40
  v_fmac_f32 v193, v145, v41
  v_fmac_f32 v194, v146, v42
  v_fmac_f32 v195, v147, v43
  v_mfma_f32_16x16x32_bf16 v[144:147], v[124:127], v[128:131], 0
  v_fmac_f32 v192, v148, v44
  v_fmac_f32 v193, v149, v45
  v_fmac_f32 v194, v150, v46
  v_fmac_f32 v195, v151, v47
  v_mfma_f32_16x16x32_bf16 v[148:151], v[128:131], v[128:131], 0
  v_fmac_f32 v192, v140, v48
  v_fmac_f32 v193, v141, v49
  v_fmac_f32 v194, v142, v50
  v_fmac_f32 v195, v143, v51
  ds_read_b128 v[112:115], v214 offset:0
  ds_read_b128 v[116:119], v214 offset:4224
  ds_read_b128 v[120:123], v214 offset:8448
  ds_read_b128 v[124:127], v214 offset:12672
  ds_read_b128 v[128:131], v214 offset:16896
  s_waitcnt lgkmcnt(5)
  v_mfma_f32_16x16x32_bf16 v[140:143], v[220:223], v[236:239], 0
  v_fmac_f32 v192, v144, v52
  v_fmac_f32 v193, v145, v53
  v_fmac_f32 v194, v146, v54
  v_fmac_f32 v195, v147, v55
  v_mfma_f32_16x16x32_bf16 v[144:147], v[224:227], v[236:239], 0
  v_fmac_f32 v192, v148, v56
  v_fmac_f32 v193, v149, v57
  v_fmac_f32 v194, v150, v58
  v_fmac_f32 v195, v151, v59
  v_mfma_f32_16x16x32_bf16 v[148:151], v[228:231], v[236:239], 0
  v_fmac_f32 v196, v140, v40
  v_fmac_f32 v197, v141, v41
  v_fmac_f32 v198, v142, v42
  v_fmac_f32 v199, v143, v43
  v_mfma_f32_16x16x32_bf16 v[140:143], v[232:235], v[236:239], 0
  v_fmac_f32 v196, v144, v44
  v_fmac_f32 v197, v145, v45
  v_fmac_f32 v198, v146, v46
  v_fmac_f32 v199, v147, v47
  v_mfma_f32_16x16x32_bf16 v[144:147], v[236:239], v[236:239], 0
  v_fmac_f32 v196, v148, v48
  v_fmac_f32 v197, v149, v49
  v_fmac_f32 v198, v150, v50
  v_fmac_f32 v199, v151, v51
  ds_read_b128 v[220:223], v215 offset:0
  ds_read_b128 v[224:227], v215 offset:4224
  ds_read_b128 v[228:231], v215 offset:8448
  ds_read_b128 v[232:235], v215 offset:12672
  ds_read_b128 v[236:239], v215 offset:16896
  s_waitcnt lgkmcnt(5)
  v_mfma_f32_16x16x32_bf16 v[148:151], v[112:115], v[128:131], 0
  v_fmac_f32 v196, v140, v52
  v_fmac_f32 v197, v141, v53
  v_fmac_f32 v198, v142, v54
  v_fmac_f32 v199, v143, v55
  v_mfma_f32_16x16x32_bf16 v[140:143], v[116:119], v[128:131], 0
  v_fmac_f32 v196, v144, v56
  v_fmac_f32 v197, v145, v57
  v_fmac_f32 v198, v146, v58
  v_fmac_f32 v199, v147, v59
  v_mfma_f32_16x16x32_bf16 v[144:147], v[120:123], v[128:131], 0
  v_fmac_f32 v200, v148, v40
  v_fmac_f32 v201, v149, v41
  v_fmac_f32 v202, v150, v42
  v_fmac_f32 v203, v151, v43
  v_mfma_f32_16x16x32_bf16 v[148:151], v[124:127], v[128:131], 0
  v_fmac_f32 v200, v140, v44
  v_fmac_f32 v201, v141, v45
  v_fmac_f32 v202, v142, v46
  v_fmac_f32 v203, v143, v47
  v_mfma_f32_16x16x32_bf16 v[140:143], v[128:131], v[128:131], 0
  v_fmac_f32 v200, v144, v48
  v_fmac_f32 v201, v145, v49
  v_fmac_f32 v202, v146, v50
  v_fmac_f32 v203, v147, v51
  s_waitcnt vmcnt(1)
  s_waitcnt vmcnt(0)
  s_mov_b64 exec, 1
  v_mov_b32 v250, 1
  ds_add_u32 v255, v250 offset:24
  s_mov_b64 exec, -1
  ds_read_b128 v[112:115], v212 offset:0
  ds_read_b128 v[116:119], v212 offset:4224
  ds_read_b128 v[120:123], v212 offset:8448
  ds_read_b128 v[124:127], v212 offset:12672
  ds_read_b128 v[128:131], v212 offset:16896
  ds_read_b128 v[132:135], v212 offset:21120
  s_waitcnt lgkmcnt(6)
  v_mfma_f32_16x16x32_bf16 v[144:147], v[220:223], v[236:239], 0
  v_fmac_f32 v200, v148, v52
  v_fmac_f32 v201, v149, v53
  v_fmac_f32 v202, v150, v54
  v_fmac_f32 v203, v151, v55
  v_mfma_f32_16x16x32_bf16 v[148:151], v[224:227], v[236:239], 0
  v_fmac_f32 v200, v140, v56
  v_fmac_f32 v201, v141, v57
  v_fmac_f32 v202, v142, v58
  v_fmac_f32 v203, v143, v59
  v_mfma_f32_16x16x32_bf16 v[140:143], v[228:231], v[236:239], 0
  v_fmac_f32 v204, v144, v40
  v_fmac_f32 v205, v145, v41
  v_fmac_f32 v206, v146, v42
  v_fmac_f32 v207, v147, v43
  v_mfma_f32_16x16x32_bf16 v[144:147], v[232:235], v[236:239], 0
  v_fmac_f32 v204, v148, v44
  v_fmac_f32 v205, v149, v45
  v_fmac_f32 v206, v150, v46
  v_fmac_f32 v207, v151, v47
  v_mfma_f32_16x16x32_bf16 v[148:151], v[236:239], v[236:239], 0
  v_fmac_f32 v204, v140, v48
  v_fmac_f32 v205, v141, v49
  v_fmac_f32 v206, v142, v50
  v_fmac_f32 v207, v143, v51
  ds_read_b128 v[220:223], v213 offset:0
  ds_read_b128 v[224:227], v213 offset:4224
  ds_read_b128 v[228:231], v213 offset:8448
  ds_read_b128 v[232:235], v213 offset:12672
  ds_read_b128 v[236:239], v213 offset:16896
  ds_read_b128 v[240:243], v213 offset:21120
  s_waitcnt lgkmcnt(6)
  v_mfma_f32_16x16x32_bf16 v[140:143], v[112:115], v[132:135], 0
  v_fmac_f32 v204, v144, v52
  v_fmac_f32 v205, v145, v53
  v_fmac_f32 v206, v146, v54
  v_fmac_f32 v207, v147, v55
  v_mfma_f32_16x16x32_bf16 v[144:147], v[116:119], v[132:135], 0
  v_fmac_f32 v204, v148, v56
  v_fmac_f32 v205, v149, v57
  v_fmac_f32 v206, v150, v58
  v_fmac_f32 v207, v151, v59
  v_mfma_f32_16x16x32_bf16 v[148:151], v[120:123], v[132:135], 0
  v_fmac_f32 v192, v140, v60
  v_fmac_f32 v193, v141, v61
  v_fmac_f32 v194, v142, v62
  v_fmac_f32 v195, v143, v63
  v_mfma_f32_16x16x32_bf16 v[140:143], v[124:127], v[132:135], 0
  v_fmac_f32 v192, v144, v64
  v_fmac_f32 v193, v145, v65
  v_fmac_f32 v194, v146, v66
  v_fmac_f32 v195, v147, v67
  v_mfma_f32_16x16x32_bf16 v[144:147], v[128:131], v[132:135], 0
  v_fmac_f32 v192, v148, v68
  v_fmac_f32 v193, v149, v69
  v_fmac_f32 v194, v150, v70
  v_fmac_f32 v195, v151, v71
  v_mfma_f32_16x16x32_bf16 v[148:151], v[132:135], v[132:135], 0
  v_fmac_f32 v192, v140, v72
  v_fmac_f32 v193, v141, v73
  v_fmac_f32 v194, v142, v74
  v_fmac_f32 v195, v143, v75
  ds_read_b128 v[112:115], v214 offset:0
  ds_read_b128 v[116:119], v214 offset:4224
  ds_read_b128 v[120:123], v214 offset:8448
  ds_read_b128 v[124:127], v214 offset:12672
  ds_read_b128 v[128:131], v214 offset:16896
  ds_read_b128 v[132:135], v214 offset:21120
  s_waitcnt lgkmcnt(6)
  v_mfma_f32_16x16x32_bf16 v[140:143], v[220:223], v[240:243], 0
  v_fmac_f32 v192, v144, v76
  v_fmac_f32 v193, v145, v77
  v_fmac_f32 v194, v146, v78
  v_fmac_f32 v195, v147, v79
  v_mfma_f32_16x16x32_bf16 v[144:147], v[224:227], v[240:243], 0
  v_fmac_f32 v192, v148, v80
  v_fmac_f32 v193, v149, v81
  v_fmac_f32 v194, v150, v82
  v_fmac_f32 v195, v151, v83
  v_mfma_f32_16x16x32_bf16 v[148:151], v[228:231], v[240:243], 0
  v_fmac_f32 v196, v140, v60
  v_fmac_f32 v197, v141, v61
  v_fmac_f32 v198, v142, v62
  v_fmac_f32 v199, v143, v63
  v_mfma_f32_16x16x32_bf16 v[140:143], v[232:235], v[240:243], 0
  v_fmac_f32 v196, v144, v64
  v_fmac_f32 v197, v145, v65
  v_fmac_f32 v198, v146, v66
  v_fmac_f32 v199, v147, v67
  v_mfma_f32_16x16x32_bf16 v[144:147], v[236:239], v[240:243], 0
  v_fmac_f32 v196, v148, v68
  v_fmac_f32 v197, v149, v69
  v_fmac_f32 v198, v150, v70
  v_fmac_f32 v199, v151, v71
  v_mfma_f32_16x16x32_bf16 v[148:151], v[240:243], v[240:243], 0
  v_fmac_f32 v196, v140, v72
  v_fmac_f32 v197, v141, v73
  v_fmac_f32 v198, v142, v74
  v_fmac_f32 v199, v143, v75
  ds_read_b128 v[220:223], v215 offset:0
  ds_read_b128 v[224:227], v215 offset:4224
  ds_read_b128 v[228:231], v215 offset:8448
  ds_read_b128 v[232:235], v215 offset:12672
  ds_read_b128 v[236:239], v215 offset:16896
  ds_read_b128 v[240:243], v215 offset:21120
  s_waitcnt lgkmcnt(6)
  v_mfma_f32_16x16x32_bf16 v[140:143], v[112:115], v[132:135], 0
  v_fmac_f32 v196, v144, v76
  v_fmac_f32 v197, v145, v77
  v_fmac_f32 v198, v146, v78
  v_fmac_f32 v199, v147, v79
  v_mfma_f32_16x16x32_bf16 v[144:147], v[116:119], v[132:135], 0
  v_fmac_f32 v196, v148, v80
  v_fmac_f32 v197, v149, v81
  v_fmac_f32 v198, v150, v82
  v_fmac_f32 v199, v151, v83
  v_mfma_f32_16x16x32_bf16 v[148:151], v[120:123], v[132:135], 0
  v_fmac_f32 v200, v140, v60
  v_fmac_f32 v201, v141, v61
  v_fmac_f32 v202, v142, v62
  v_fmac_f32 v203, v143, v63
  v_mfma_f32_16x16x32_bf16 v[140:143], v[124:127], v[132:135], 0
  v_fmac_f32 v200, v144, v64
  v_fmac_f32 v201, v145, v65
  v_fmac_f32 v202, v146, v66
  v_fmac_f32 v203, v147, v67
  v_mfma_f32_16x16x32_bf16 v[144:147], v[128:131], v[132:135], 0
  v_fmac_f32 v200, v148, v68
  v_fmac_f32 v201, v149, v69
  v_fmac_f32 v202, v150, v70
  v_fmac_f32 v203, v151, v71
  v_mfma_f32_16x16x32_bf16 v[148:151], v[132:135], v[132:135], 0
  v_fmac_f32 v200, v140, v72
  v_fmac_f32 v201, v141, v73
  v_fmac_f32 v202, v142, v74
  v_fmac_f32 v203, v143, v75
  s_waitcnt vmcnt(0)
  ds_read_b128 v[112:115], v212 offset:0
  ds_read_b128 v[116:119], v212 offset:4224
  ds_read_b128 v[120:123], v212 offset:8448
  ds_read_b128 v[124:127], v212 offset:12672
  ds_read_b128 v[128:131], v212 offset:16896
  ds_read_b128 v[132:135], v212 offset:21120
  ds_read_b128 v[136:139], v216 offset:25344
  s_waitcnt lgkmcnt(7)
  v_mfma_f32_16x16x32_bf16 v[140:143], v[220:223], v[240:243], 0
  v_fmac_f32 v200, v144, v76
  v_fmac_f32 v201, v145, v77
  v_fmac_f32 v202, v146, v78
  v_fmac_f32 v203, v147, v79
  v_mfma_f32_16x16x32_bf16 v[144:147], v[224:227], v[240:243], 0
  v_fmac_f32 v200, v148, v80
  v_fmac_f32 v201, v149, v81
  v_fmac_f32 v202, v150, v82
  v_fmac_f32 v203, v151, v83
  v_mfma_f32_16x16x32_bf16 v[148:151], v[228:231], v[240:243], 0
  v_fmac_f32 v204, v140, v60
  v_fmac_f32 v205, v141, v61
  v_fmac_f32 v206, v142, v62
  v_fmac_f32 v207, v143, v63
  v_mfma_f32_16x16x32_bf16 v[140:143], v[232:235], v[240:243], 0
  v_fmac_f32 v204, v144, v64
  v_fmac_f32 v205, v145, v65
  v_fmac_f32 v206, v146, v66
  v_fmac_f32 v207, v147, v67
  v_mfma_f32_16x16x32_bf16 v[144:147], v[236:239], v[240:243], 0
  v_fmac_f32 v204, v148, v68
  v_fmac_f32 v205, v149, v69
  v_fmac_f32 v206, v150, v70
  v_fmac_f32 v207, v151, v71
  v_mfma_f32_16x16x32_bf16 v[148:151], v[240:243], v[240:243], 0
  v_fmac_f32 v204, v140, v72
  v_fmac_f32 v205, v141, v73
  v_fmac_f32 v206, v142, v74
  v_fmac_f32 v207, v143, v75
  ds_read_b128 v[220:223], v213 offset:0
  ds_read_b128 v[224:227], v213 offset:4224
  ds_read_b128 v[228:231], v213 offset:8448
  ds_read_b128 v[232:235], v213 offset:12672
  ds_read_b128 v[236:239], v213 offset:16896
  ds_read_b128 v[240:243], v213 offset:21120
  ds_read_b128 v[244:247], v217 offset:25344
  s_waitcnt lgkmcnt(7)
  v_mfma_f32_16x16x32_bf16 v[140:143], v[112:115], v[136:139], 0
  v_fmac_f32 v204, v144, v76
  v_fmac_f32 v205, v145, v77
  v_fmac_f32 v206, v146, v78
  v_fmac_f32 v207, v147, v79
  v_mfma_f32_16x16x32_bf16 v[144:147], v[116:119], v[136:139], 0
  v_fmac_f32 v204, v148, v80
  v_fmac_f32 v205, v149, v81
  v_fmac_f32 v206, v150, v82
  v_fmac_f32 v207, v151, v83
  v_mfma_f32_16x16x32_bf16 v[148:151], v[120:123], v[136:139], 0
  v_fmac_f32 v192, v140, v84
  v_fmac_f32 v193, v141, v85
  v_fmac_f32 v194, v142, v86
  v_fmac_f32 v195, v143, v87
  v_mfma_f32_16x16x32_bf16 v[140:143], v[124:127], v[136:139], 0
  v_fmac_f32 v192, v144, v88
  v_fmac_f32 v193, v145, v89
  v_fmac_f32 v194, v146, v90
  v_fmac_f32 v195, v147, v91
  v_mfma_f32_16x16x32_bf16 v[144:147], v[128:131], v[136:139], 0
  v_fmac_f32 v192, v148, v92
  v_fmac_f32 v193, v149, v93
  v_fmac_f32 v194, v150, v94
  v_fmac_f32 v195, v151, v95
  v_mfma_f32_16x16x32_bf16 v[148:151], v[132:135], v[136:139], 0
  v_fmac_f32 v192, v140, v96
  v_fmac_f32 v193, v141, v97
  v_fmac_f32 v194, v142, v98
  v_fmac_f32 v195, v143, v99
  v_mfma_f32_16x16x32_bf16 v[140:143], v[136:139], v[136:139], 0
  v_fmac_f32 v192, v144, v100
  v_fmac_f32 v193, v145, v101
  v_fmac_f32 v194, v146, v102
  v_fmac_f32 v195, v147, v103
  ds_read_b128 v[112:115], v214 offset:0
  ds_read_b128 v[116:119], v214 offset:4224
  ds_read_b128 v[120:123], v214 offset:8448
  ds_read_b128 v[124:127], v214 offset:12672
  ds_read_b128 v[128:131], v214 offset:16896
  ds_read_b128 v[132:135], v214 offset:21120
  ds_read_b128 v[136:139], v218 offset:25344
  s_waitcnt lgkmcnt(7)
  v_mfma_f32_16x16x32_bf16 v[144:147], v[220:223], v[244:247], 0
  v_fmac_f32 v192, v148, v104
  v_fmac_f32 v193, v149, v105
  v_fmac_f32 v194, v150, v106
  v_fmac_f32 v195, v151, v107
  v_mfma_f32_16x16x32_bf16 v[148:151], v[224:227], v[244:247], 0
  v_fmac_f32 v192, v140, v108
  v_fmac_f32 v193, v141, v109
  v_fmac_f32 v194, v142, v110
  v_fmac_f32 v195, v143, v111
  v_mfma_f32_16x16x32_bf16 v[140:143], v[228:231], v[244:247], 0
  v_fmac_f32 v196, v144, v84
  v_fmac_f32 v197, v145, v85
  v_fmac_f32 v198, v146, v86
  v_fmac_f32 v199, v147, v87
  v_mfma_f32_16x16x32_bf16 v[144:147], v[232:235], v[244:247], 0
  v_fmac_f32 v196, v148, v88
  v_fmac_f32 v197, v149, v89
  v_fmac_f32 v198, v150, v90
  v_fmac_f32 v199, v151, v91
  v_mfma_f32_16x16x32_bf16 v[148:151], v[236:239], v[244:247], 0
  v_fmac_f32 v196, v140, v92
  v_fmac_f32 v197, v141, v93
  v_fmac_f32 v198, v142, v94
  v_fmac_f32 v199, v143, v95
  v_mfma_f32_16x16x32_bf16 v[140:143], v[240:243], v[244:247], 0
  v_fmac_f32 v196, v144, v96
  v_fmac_f32 v197, v145, v97
  v_fmac_f32 v198, v146, v98
  v_fmac_f32 v199, v147, v99
  v_mfma_f32_16x16x32_bf16 v[144:147], v[244:247], v[244:247], 0
  v_fmac_f32 v196, v148, v100
  v_fmac_f32 v197, v149, v101
  v_fmac_f32 v198, v150, v102
  v_fmac_f32 v199, v151, v103
  ds_read_b128 v[220:223], v215 offset:0
  ds_read_b128 v[224:227], v215 offset:4224
  ds_read_b128 v[228:231], v215 offset:8448
  ds_read_b128 v[232:235], v215 offset:12672
  ds_read_b128 v[236:239], v215 offset:16896
  ds_read_b128 v[240:243], v215 offset:21120
  ds_read_b128 v[244:247], v219 offset:25344
  s_waitcnt lgkmcnt(7)
  v_mfma_f32_16x16x32_bf16 v[148:151], v[112:115], v[136:139], 0
  v_fmac_f32 v196, v140, v104
  v_fmac_f32 v197, v141, v105
  v_fmac_f32 v198, v142, v106
  v_fmac_f32 v199, v143, v107
  v_mfma_f32_16x16x32_bf16 v[140:143], v[116:119], v[136:139], 0
  v_fmac_f32 v196, v144, v108
  v_fmac_f32 v197, v145, v109
  v_fmac_f32 v198, v146, v110
  v_fmac_f32 v199, v147, v111
  v_mfma_f32_16x16x32_bf16 v[144:147], v[120:123], v[136:139], 0
  v_fmac_f32 v200, v148, v84
  v_fmac_f32 v201, v149, v85
  v_fmac_f32 v202, v150, v86
  v_fmac_f32 v203, v151, v87
  v_mfma_f32_16x16x32_bf16 v[148:151], v[124:127], v[136:139], 0
  v_fmac_f32 v200, v140, v88
  v_fmac_f32 v201, v141, v89
  v_fmac_f32 v202, v142, v90
  v_fmac_f32 v203, v143, v91
  v_mfma_f32_16x16x32_bf16 v[140:143], v[128:131], v[136:139], 0
  v_fmac_f32 v200, v144, v92
  v_fmac_f32 v201, v145, v93
  v_fmac_f32 v202, v146, v94
  v_fmac_f32 v203, v147, v95
  v_mfma_f32_16x16x32_bf16 v[144:147], v[132:135], v[136:139], 0
  v_fmac_f32 v200, v148, v96
  v_fmac_f32 v201, v149, v97
  v_fmac_f32 v202, v150, v98
  v_fmac_f32 v203, v151, v99
  v_mfma_f32_16x16x32_bf16 v[148:151], v[136:139], v[136:139], 0
  v_fmac_f32 v200, v140, v100
  v_fmac_f32 v201, v141, v101
  v_fmac_f32 v202, v142, v102
  v_fmac_f32 v203, v143, v103
  s_waitcnt lgkmcnt(0)
  v_mfma_f32_16x16x32_bf16 v[140:143], v[220:223], v[244:247], 0
  v_fmac_f32 v200, v144, v104
  v_fmac_f32 v201, v145, v105
  v_fmac_f32 v202, v146, v106
  v_fmac_f32 v203, v147, v107
  v_mfma_f32_16x16x32_bf16 v[144:147], v[224:227], v[244:247], 0
  v_fmac_f32 v200, v148, v108
  v_fmac_f32 v201, v149, v109
  v_fmac_f32 v202, v150, v110
  v_fmac_f32 v203, v151, v111
  v_mfma_f32_16x16x32_bf16 v[148:151], v[228:231], v[244:247], 0
  v_fmac_f32 v204, v140, v84
  v_fmac_f32 v205, v141, v85
  v_fmac_f32 v206, v142, v86
  v_fmac_f32 v207, v143, v87
  v_mfma_f32_16x16x32_bf16 v[140:143], v[232:235], v[244:247], 0
  v_fmac_f32 v204, v144, v88
  v_fmac_f32 v205, v145, v89
  v_fmac_f32 v206, v146, v90
  v_fmac_f32 v207, v147, v91
  v_mfma_f32_16x16x32_bf16 v[144:147], v[236:239], v[244:247], 0
  v_fmac_f32 v204, v148, v92
  v_fmac_f32 v205, v149, v93
  v_fmac_f32 v206, v150, v94
  v_fmac_f32 v207, v151, v95
  v_mfma_f32_16x16x32_bf16 v[148:151], v[240:243], v[244:247], 0
  v_fmac_f32 v204, v140, v96
  v_fmac_f32 v205, v141, v97
  v_fmac_f32 v206, v142, v98
  v_fmac_f32 v207, v143, v99
  v_mfma_f32_16x16x32_bf16 v[140:143], v[244:247], v[244:247], 0
  v_fmac_f32 v204, v144, v100
  v_fmac_f32 v205, v145, v101
  v_fmac_f32 v206, v146, v102
  v_fmac_f32 v207, v147, v103
  s_nop 5
  v_fmac_f32 v204, v148, v104
  v_fmac_f32 v205, v149, v105
  v_fmac_f32 v206, v150, v106
  v_fmac_f32 v207, v151, v107
  v_fmac_f32 v204, v140, v108
  v_fmac_f32 v205, v141, v109
  v_fmac_f32 v206, v142, v110
  v_fmac_f32 v207, v143, v111
  v_add_f32 v192, v192, v193
  v_add_f32 v194, v194, v195
  v_add_f32 v196, v196, v197
  v_add_f32 v198, v198, v199
  v_add_f32 v200, v200, v201
  v_add_f32 v202, v202, v203
  v_add_f32 v204, v204, v205
  v_add_f32 v206, v206, v207
  v_add_f32 v208, v192, v194
  v_add_f32 v209, v196, v198
  v_add_f32 v210, v200, v202
  v_add_f32 v211, v204, v206
  s_nop 1
  v_add_f32_dpp v208, v208, v208 row_shr:1 row_mask:0xf bank_mask:0xf
  v_add_f32_dpp v209, v209, v209 row_shr:1 row_mask:0xf bank_mask:0xf
  v_add_f32_dpp v210, v210, v210 row_shr:1 row_mask:0xf bank_mask:0xf
  v_add_f32_dpp v211, v211, v211 row_shr:1 row_mask:0xf bank_mask:0xf
  v_add_f32_dpp v208, v208, v208 row_shr:2 row_mask:0xf bank_mask:0xf
  v_add_f32_dpp v209, v209, v209 row_shr:2 row_mask:0xf bank_mask:0xf
  v_add_f32_dpp v210, v210, v210 row_shr:2 row_mask:0xf bank_mask:0xf
  v_add_f32_dpp v211, v211, v211 row_shr:2 row_mask:0xf bank_mask:0xf
  v_add_f32_dpp v208, v208, v208 row_shr:4 row_mask:0xf bank_mask:0xf
  v_add_f32_dpp v209, v209, v209 row_shr:4 row_mask:0xf bank_mask:0xf
  v_add_f32_dpp v210, v210, v210 row_shr:4 row_mask:0xf bank_mask:0xf
  v_add_f32_dpp v211, v211, v211 row_shr:4 row_mask:0xf bank_mask:0xf
  v_add_f32_dpp v208, v208, v208 row_shr:8 row_mask:0xf bank_mask:0xf
  v_add_f32_dpp v209, v209, v209 row_shr:8 row_mask:0xf bank_mask:0xf
  v_add_f32_dpp v210, v210, v210 row_shr:8 row_mask:0xf bank_mask:0xf
  v_add_f32_dpp v211, v211, v211 row_shr:8 row_mask:0xf bank_mask:0xf
  v_add_f32_dpp v208, v208, v208 row_bcast:15 row_mask:0xa bank_mask:0xf
  v_add_f32_dpp v209, v209, v209 row_bcast:15 row_mask:0xa bank_mask:0xf
  v_add_f32_dpp v210, v210, v210 row_bcast:15 row_mask:0xa bank_mask:0xf
  v_add_f32_dpp v211, v211, v211 row_bcast:15 row_mask:0xa bank_mask:0xf
  v_add_f32_dpp v208, v208, v208 row_bcast:31 row_mask:0xc bank_mask:0xf
  v_add_f32_dpp v209, v209, v209 row_bcast:31 row_mask:0xc bank_mask:0xf
  v_add_f32_dpp v210, v210, v210 row_bcast:31 row_mask:0xc bank_mask:0xf
  v_add_f32_dpp v211, v211, v211 row_bcast:31 row_mask:0xc bank_mask:0xf
  s_lshl_b32 s39, s39, 16
  s_lshl_b32 s24, s95, 4
  s_add_u32 s24, s24, 161888
  v_mov_b32 v212, s24
  s_lshl_b32 s36, s34, 6
  s_lshl_b32 s37, s35, 4
  s_add_u32 s36, s36, s37
  s_lshl_b32 s37, s95, 2
  s_add_u32 s36, s36, s37
  s_lshl_b32 s36, s36, 1
  v_mov_b32 v42, s36
  s_barrier
  ds_read_b128 v[216:219], v212 offset:0
  ds_read_b128 v[220:223], v212 offset:64
  ds_read_b128 v[224:227], v212 offset:128
  ds_read_b128 v[228:231], v212 offset:192
  s_waitcnt lgkmcnt(0)
  v_add_f32 v216, v216, v220
  v_add_f32 v224, v224, v228
  v_add_f32 v217, v217, v221
  v_add_f32 v225, v225, v229
  v_add_f32 v218, v218, v222
  v_add_f32 v226, v226, v230
  v_add_f32 v219, v219, v223
  v_add_f32 v227, v227, v231
  v_add_f32 v216, v216, v224
  v_add_f32 v217, v217, v225
  v_add_f32 v218, v218, v226
  v_add_f32 v219, v219, v227
  v_add_f32 v208, v208, v216
  v_add_f32 v209, v209, v217
  v_add_f32 v210, v210, v218
  v_add_f32 v211, v211, v219
  v_add_f32 v208, s39, v208
  v_add_f32 v209, s39, v209
  v_add_f32 v210, s39, v210
  v_add_f32 v211, s39, v211
  v_cvt_pk_bf16_f32 v40, v208, v209
  v_cvt_pk_bf16_f32 v41, v210, v211
  s_mov_b32 exec_lo, 0
  s_mov_b32 exec_hi, 0x80000000
  buffer_store_dwordx2 v[40:41], v42, s[28:31], 0 offen
L_end:
  s_endpgm
.section .rodata,"a"
.p2align 6
.amdhsa_kernel standalone__deep_cross_pnn__recsys_kernel
  .amdhsa_next_free_vgpr 256
  .amdhsa_next_free_sgpr 102
  .amdhsa_accum_offset 256
  .amdhsa_group_segment_fixed_size 0
  .amdhsa_kernarg_size 80
  .amdhsa_user_sgpr_count 2
  .amdhsa_user_sgpr_kernarg_segment_ptr 1
  .amdhsa_system_sgpr_workgroup_id_x 1
.end_amdhsa_kernel
```
